```python
import torch

def _softmax(x, axis=-1):
    return torch.softmax(x, dim=axis)
def _gelu(x):
    return torch.nn.functional.gelu(x, approximate="tanh")
def _silu(x):
    return torch.nn.functional.silu(x)
def _sigmoid(x):
    return torch.sigmoid(x)
def _layernorm(x, axis=-1, eps=1e-5):
    m = x.mean(dim=axis, keepdim=True)
    v = x.var(dim=axis, keepdim=True, unbiased=False)
    return (x - m) / torch.sqrt(v + eps)
def _scatter_add(tgt, idx, src, axis=0):
    return tgt.clone().index_add_(axis, idx, src)
def _segment_sum(src, seg, n):
    out = torch.zeros((n,) + src.shape[1:], dtype=src.dtype)
    return out.index_add_(0, seg, src)
def _pad(x, pw):
    flat = tuple(v for pair in reversed(pw) for v in pair)
    return torch.nn.functional.pad(x, flat)

kernel_name = 'parallel_sum__gqa_block_cached__swiglu_ffn__decode'

def setup_inputs():

    _w = (lambda a: (lambda t: t.to(torch.bfloat16) if t.is_floating_point() else t)(torch.as_tensor(a)))
    def _A_setup():
        B, Sq, D = 8, 1, 576
        Hq, Hkv, Sk, Dh = 32, 16, 8192, 128
        assert Hq % Hkv == 0, (Hq, Hkv)
        return {
            "x": _w((lambda *s: torch.randn(*s, dtype=torch.bfloat16) * 0.05)(B, Sq, D)),
            "k_cache": _w((lambda *s: torch.randn(*s, dtype=torch.bfloat16) * 3.2)(B, Hkv, Sk, Dh)),
            "v_cache": _w((lambda *s: torch.randn(*s, dtype=torch.bfloat16) * 1.6)(B, Hkv, Sk, Dh)),
            "wq": _w((lambda *s: torch.randn(*s, dtype=torch.bfloat16) * 3.2)(D, Hq * Dh) * (D ** -0.5)),
            "wo": _w((lambda *s: torch.randn(*s, dtype=torch.bfloat16) * 1.6)(Hq * Dh, D) * ((Hq * Dh) ** -0.5)),
        }
    _A_in = _A_setup()

    def _B_setup():
        B, S, D, F = 8, 1, 576, 4608
        return {
            "x": _w((lambda *s: torch.randn(*s, dtype=torch.bfloat16) * 0.05)(B, S, D)),
            "w_gate": _w((lambda *s: torch.randn(*s, dtype=torch.bfloat16) * 0.05)(D, F)),
            "w_up": _w((lambda *s: torch.randn(*s, dtype=torch.bfloat16) * 0.05)(D, F)),
            "w_down": _w((lambda *s: torch.randn(*s, dtype=torch.bfloat16) * 0.05)(F, D)),
        }
    _B_in = _B_setup()

    return {
        "A_x": _A_in["x"],
        "A_k_cache": _A_in["k_cache"],
        "A_v_cache": _A_in["v_cache"],
        "A_wq": _A_in["wq"],
        "A_wo": _A_in["wo"],
        "B_x": _B_in["x"],
        "B_w_gate": _B_in["w_gate"],
        "B_w_up": _B_in["w_up"],
        "B_w_down": _B_in["w_down"],
    }

def reference(A_x, A_k_cache, A_v_cache, A_wq, A_wo, B_x, B_w_gate, B_w_up, B_w_down):
    def _A_ref(x, k_cache, v_cache, wq, wo):
        B, Sq, D = x.shape
        Hq, Dh = 32, 128
        Hkv = k_cache.shape[1]
        rep = Hq // Hkv
        q = (lambda x, *d: x.permute(*d))((x @ wq).reshape(B, Sq, Hq, Dh), 0, 2, 1, 3)
        k = (lambda x, n, axis: torch.repeat_interleave(x, n, dim=axis))(k_cache, rep, axis=1)
        v = (lambda x, n, axis: torch.repeat_interleave(x, n, dim=axis))(v_cache, rep, axis=1)
        scores = torch.einsum("bhqd,bhkd->bhqk", q, k) * (Dh ** -0.5)
        p = _softmax(scores, axis=-1)
        o = torch.einsum("bhqk,bhkd->bhqd", p, v)
        return (lambda x, *d: x.permute(*d))(o, 0, 2, 1, 3).reshape(B, Sq, Hq * Dh) @ wo

    def _B_ref(x, w_gate, w_up, w_down):
        g = _silu(x @ w_gate)
        u = x @ w_up
        return (g * u) @ w_down

    x = A_x
    xn = _layernorm(x, axis=-1)
    return x + _A_ref(xn, A_k_cache, A_v_cache, A_wq, A_wo) + _B_ref(xn, B_w_gate, B_w_up, B_w_down)
```

```asm
; @launch grid=(256,1,1) block=(1024,1,1) lds=133696
.amdgcn_target "amdgcn-amd-amdhsa--gfx950"
.text
.globl parallel_sum__gqa_block_cached__swiglu_ffn__decode_kernel
.p2align 8
.type parallel_sum__gqa_block_cached__swiglu_ffn__decode_kernel,@function
parallel_sum__gqa_block_cached__swiglu_ffn__decode_kernel:
  s_cmp_ge_u32 s2, 256
  s_cbranch_scc1 L_exit
  s_load_dwordx16 s[4:19], s[0:1], 0
  s_load_dwordx8 s[20:27], s[0:1], 64
  v_lshrrev_b32 v1, 6, v0
  v_and_b32 v0, 63, v0
  v_readfirstlane_b32 s3, v1
  v_mov_b32 v2, 0
  v_mov_b32 v3, 0
  v_mov_b32 v4, 0
  v_mov_b32 v5, 0
  v_mov_b32 v6, 0
  v_mov_b32 v7, 0
  s_bfe_u32 s30, s2, 0x10001
  s_xor_b32 s61, s2, s30
  s_and_b32 s61, s61, 1
  s_bfe_u32 s28, s2, 0x10002
  s_lshl_b32 s28, s28, 1
  s_add_u32 s28, s28, s61
  s_lshl_b32 s28, s28, 2
  s_bfe_u32 s61, s2, 0x20003
  s_add_u32 s28, s28, s61
  s_lshr_b32 s29, s2, 5
  s_lshl_b32 s31, s29, 1
  s_add_u32 s31, s31, s30
  s_mov_b32 s48, 0x05040100
  s_mov_b32 s49, 0x07060302
  s_mov_b32 s64, 0x3fb8aa3b
  s_mov_b32 s65, 0x3db504f3
  s_mov_b32 s66, 0xffff0000
  s_mov_b32 s67, 0xfffffffe
  s_mov_b32 s81, -1
  s_waitcnt lgkmcnt(0)
  s_mov_b32 s44, s26
  s_mov_b32 s45, s27
  s_mov_b32 s46, 4194304
  s_mov_b32 s47, 0x20000
  s_add_u32 s57, s26, 1253376
  s_addc_u32 s61, s27, 0
  s_mov_b32 s62, s57
  s_mov_b32 s63, s61
  s_load_dword s70, s[62:63], 0
  s_cmp_ge_u32 s3, 8
  s_nop 0
  s_cbranch_scc1 L_aux
  s_cmp_ge_u32 s3, 4
  s_nop 0
  s_cbranch_scc1 L_idle
  s_cmp_lg_u32 s3, 1
  s_nop 0
  s_cbranch_scc1 L_s_t1
  s_mov_b32 s40, s26
  s_mov_b32 s41, s27
  s_mov_b32 s42, 4194304
  s_mov_b32 s43, 0x20000
  v_lshlrev_b32 v4, 20, v0
  v_cmp_gt_u32 vcc, 4, v0
  s_nop 0
  s_and_saveexec_b64 s[68:69], vcc
  buffer_load_dword v8, v4, s[40:43], 0 offen
  s_mov_b64 exec, s[68:69]
  s_mov_b32 s40, s12
  s_mov_b32 s41, s13
  s_mov_b32 s42, 4718592
  s_mov_b32 s43, 0x20000
  v_lshlrev_b32 v4, 20, v0
  v_cmp_gt_u32 vcc, 5, v0
  s_nop 0
  s_and_saveexec_b64 s[68:69], vcc
  buffer_load_dword v9, v4, s[40:43], 0 offen
  s_mov_b64 exec, s[68:69]
  s_mov_b32 s40, s22
  s_mov_b32 s41, s23
  s_mov_b32 s42, 9216
  s_mov_b32 s43, 0x20000
  v_lshlrev_b32 v4, 20, v0
  v_cmp_gt_u32 vcc, 1, v0
  s_nop 0
  s_and_saveexec_b64 s[68:69], vcc
  buffer_load_dword v10, v4, s[40:43], 0 offen
  s_mov_b64 exec, s[68:69]
L_s_t1:
  s_cmp_lg_u32 s3, 2
  s_nop 0
  s_cbranch_scc1 L_s_t2
  s_mov_b32 s40, s16
  s_mov_b32 s41, s17
  s_mov_b32 s42, 5308416
  s_mov_b32 s43, 0x20000
  v_lshlrev_b32 v4, 20, v0
  v_cmp_gt_u32 vcc, 6, v0
  s_nop 0
  s_and_saveexec_b64 s[68:69], vcc
  buffer_load_dword v8, v4, s[40:43], 0 offen
  s_mov_b64 exec, s[68:69]
  s_mov_b32 s40, s18
  s_mov_b32 s41, s19
  s_mov_b32 s42, 5308416
  s_mov_b32 s43, 0x20000
  v_lshlrev_b32 v4, 20, v0
  v_cmp_gt_u32 vcc, 6, v0
  s_nop 0
  s_and_saveexec_b64 s[68:69], vcc
  buffer_load_dword v9, v4, s[40:43], 0 offen
  s_mov_b64 exec, s[68:69]
  s_mov_b32 s40, s24
  s_mov_b32 s41, s25
  s_mov_b32 s42, 256
  s_mov_b32 s43, 0x20000
  v_lshlrev_b32 v4, 20, v0
  v_cmp_gt_u32 vcc, 1, v0
  s_nop 0
  s_and_saveexec_b64 s[68:69], vcc
  buffer_load_dword v10, v4, s[40:43], 0 offen
  s_mov_b64 exec, s[68:69]
L_s_t2:
  s_cmp_lg_u32 s3, 3
  s_cbranch_scc1 L_s_t3
  s_mov_b32 s40, s20
  s_mov_b32 s41, s21
  s_mov_b32 s42, 5308416
  s_mov_b32 s43, 0x20000
  v_lshlrev_b32 v4, 20, v0
  v_cmp_gt_u32 vcc, 6, v0
  s_nop 0
  s_and_saveexec_b64 s[68:69], vcc
  buffer_load_dword v8, v4, s[40:43], 0 offen
  s_mov_b64 exec, s[68:69]
L_s_t3:
  s_cmp_eq_u32 s30, 0
  s_cselect_b32 s54, 0, 280
  s_lshl_b32 s57, s29, 4
  s_add_u32 s57, s57, s28
  s_lshl_b32 s57, s57, 21
  s_add_u32 s32, s6, s57
  s_addc_u32 s33, s7, 0
  s_mov_b32 s34, 2097152
  s_mov_b32 s35, 0x20000
  s_add_u32 s36, s8, s57
  s_addc_u32 s37, s9, 0
  s_mov_b32 s38, 2097152
  s_mov_b32 s39, 0x20000
  v_and_b32 v4, 15, v0
  v_lshrrev_b32 v5, 4, v0
  v_lshlrev_b32 v6, 10, v5
  v_lshl_add_u32 v1, v4, 4, v6
  v_lshlrev_b32 v6, 4, v5
  v_and_b32 v7, 1, v0
  v_lshl_add_u32 v7, v7, 8, v6
  v_lshl_add_u32 v0, v4, 8, v6
  s_cmp_lg_u32 s3, 0
  s_cbranch_scc1 L_s_nkt
  v_mbcnt_lo_u32_b32 v12, -1, 0
  v_mbcnt_hi_u32_b32 v12, -1, v12
  v_lshlrev_b32 v12, 18, v12
  s_mov_b64 exec, 0xff
  buffer_load_dword v13, v12, s[32:35], 0 offen nt
  buffer_load_dword v14, v12, s[36:39], 0 offen nt
  s_mov_b64 exec, -1
L_s_nkt:
  s_add_u32 s52, s54, s3
  s_mul_i32 s50, s52, 4096
  s_add_u32 s51, s50, 4096
  buffer_load_dwordx4 v[64:67], v0, s[32:35], s50 offen offset:0 nt
  buffer_load_dwordx4 v[68:71], v0, s[32:35], s50 offen offset:64 nt
  s_barrier
  v_mov_b32 v32, 0
  v_mov_b32 v33, 0
  v_mov_b32 v34, 0
  v_mov_b32 v35, 0
  v_mov_b32 v36, 0
  v_mov_b32 v37, 0
  v_mov_b32 v38, 0
  v_mov_b32 v39, 0
  v_mov_b32 v40, 0
  v_mov_b32 v41, 0
  v_mov_b32 v42, 0
  v_mov_b32 v43, 0
  v_mov_b32 v44, 0
  v_mov_b32 v45, 0
  v_mov_b32 v46, 0
  v_mov_b32 v47, 0
  v_mov_b32 v48, 0
  v_mov_b32 v49, 0
  v_mov_b32 v50, 0
  v_mov_b32 v51, 0
  v_mov_b32 v52, 0
  v_mov_b32 v53, 0
  v_mov_b32 v54, 0
  v_mov_b32 v55, 0
  v_mov_b32 v56, 0
  v_mov_b32 v57, 0
  v_mov_b32 v58, 0
  v_mov_b32 v59, 0
  v_mov_b32 v60, 0
  v_mov_b32 v61, 0
  v_mov_b32 v62, 0
  v_mov_b32 v63, 0
  v_mov_b32 v2, 0xff800000
  v_mov_b32 v3, 0
  s_waitcnt vmcnt(0)
  buffer_load_dwordx4 v[72:75], v0, s[32:35], s50 offen offset:128 nt
  buffer_load_dwordx4 v[76:79], v0, s[32:35], s50 offen offset:192 nt
  s_waitcnt vmcnt(0)
  buffer_load_dwordx4 v[96:99], v1, s[36:39], s50 offen offset:0 nt
  buffer_load_dwordx4 v[100:103], v1, s[36:39], s50 offen offset:256 nt
  s_waitcnt vmcnt(0)
  buffer_load_dwordx4 v[104:107], v1, s[36:39], s50 offen offset:512 nt
  buffer_load_dwordx4 v[108:111], v1, s[36:39], s50 offen offset:768 nt
  v_mov_b32 v4, 29972
  s_mov_b32 s80, 0
L_s_qw:
  ds_read_b32 v5, v4
  s_waitcnt lgkmcnt(0)
  v_readfirstlane_b32 s57, v5
  s_nop 0
  s_cmp_ge_u32 s57, 2
  s_nop 0
  s_cbranch_scc1 L_s_qok
  s_sleep 2
  s_add_u32 s80, s80, 1
  s_cmp_lt_u32 s80, 1048576
  s_nop 0
  s_cbranch_scc1 L_s_qw
L_s_qok:
  ds_read_b128 v[16:19], v7 offset:16768
  ds_read_b128 v[20:23], v7 offset:16832
  ds_read_b128 v[24:27], v7 offset:16896
  ds_read_b128 v[28:31], v7 offset:16960
  s_mov_b32 s56, 0
  s_mov_b32 s53, 0
  v_mov_b32 v4, 29984
  v_mov_b32 v5, 1
  s_mov_b64 exec, 1
  ds_add_rtn_u32 v6, v4, v5
  s_mov_b64 exec, -1
  s_waitcnt lgkmcnt(0)
  v_readfirstlane_b32 s83, v6
  s_nop 0
  s_add_u32 s83, s83, s54
L_sloop:
  s_mul_i32 s50, s83, 4096
  s_add_u32 s51, s50, 4096
  s_waitcnt vmcnt(4)
  v_mfma_f32_16x16x32_bf16 v[8:11], v[64:67], v[16:19], 0
  v_mfma_f32_16x16x32_bf16 v[8:11], v[68:71], v[20:23], v[8:11]
  v_mfma_f32_16x16x32_bf16 v[8:11], v[72:75], v[24:27], v[8:11]
  v_mfma_f32_16x16x32_bf16 v[8:11], v[76:79], v[28:31], v[8:11]
  buffer_load_dwordx4 v[64:67], v0, s[32:35], s50 offen offset:0 nt
  buffer_load_dwordx4 v[68:71], v0, s[32:35], s50 offen offset:64 nt
  buffer_load_dwordx4 v[72:75], v0, s[32:35], s50 offen offset:128 nt
  buffer_load_dwordx4 v[76:79], v0, s[32:35], s50 offen offset:192 nt
  s_nop 3
  v_cvt_pk_bf16_f32 v4, v8, v9
  v_cvt_pk_bf16_f32 v5, v10, v11
  v_lshlrev_b32 v8, 16, v4
  v_and_b32 v9, s66, v4
  v_lshlrev_b32 v10, 16, v5
  v_and_b32 v11, s66, v5
  v_mul_f32 v8, s65, v8
  v_mul_f32 v9, s65, v9
  v_mul_f32 v10, s65, v10
  v_mul_f32 v11, s65, v11
  v_cvt_pk_bf16_f32 v4, v8, v9
  v_cvt_pk_bf16_f32 v5, v10, v11
  v_lshlrev_b32 v8, 16, v4
  v_and_b32 v9, s66, v4
  v_lshlrev_b32 v10, 16, v5
  v_and_b32 v11, s66, v5
  v_max3_f32 v4, v8, v9, v10
  v_max_f32 v4, v4, v11
  v_cmp_gt_f32 vcc, v4, v2
  s_cbranch_vccz L_nores
  v_mov_b32 v5, v4
  s_nop 1
  v_permlane16_swap_b32 v4, v5
  v_max_f32 v4, v4, v5
  v_mov_b32 v5, v4
  s_nop 1
  v_permlane32_swap_b32 v4, v5
  v_max3_f32 v4, v4, v5, v2
  v_sub_f32 v6, v2, v4
  v_mul_f32 v6, s64, v6
  v_exp_f32 v6, v6
  v_mov_b32 v2, v4
  v_mov_b32 v7, v6
  v_mul_f32 v3, v3, v6
  v_pk_mul_f32 v[32:33], v[32:33], v[6:7]
  v_pk_mul_f32 v[34:35], v[34:35], v[6:7]
  v_pk_mul_f32 v[36:37], v[36:37], v[6:7]
  v_pk_mul_f32 v[38:39], v[38:39], v[6:7]
  v_pk_mul_f32 v[40:41], v[40:41], v[6:7]
  v_pk_mul_f32 v[42:43], v[42:43], v[6:7]
  v_pk_mul_f32 v[44:45], v[44:45], v[6:7]
  v_pk_mul_f32 v[46:47], v[46:47], v[6:7]
  v_pk_mul_f32 v[48:49], v[48:49], v[6:7]
  v_pk_mul_f32 v[50:51], v[50:51], v[6:7]
  v_pk_mul_f32 v[52:53], v[52:53], v[6:7]
  v_pk_mul_f32 v[54:55], v[54:55], v[6:7]
  v_pk_mul_f32 v[56:57], v[56:57], v[6:7]
  v_pk_mul_f32 v[58:59], v[58:59], v[6:7]
  v_pk_mul_f32 v[60:61], v[60:61], v[6:7]
  v_pk_mul_f32 v[62:63], v[62:63], v[6:7]
L_nores:
  v_mul_f32 v4, s64, v2
  v_fma_f32 v8, v8, s64, -v4
  v_fma_f32 v9, v9, s64, -v4
  v_fma_f32 v10, v10, s64, -v4
  v_fma_f32 v11, v11, s64, -v4
  v_exp_f32 v8, v8
  v_exp_f32 v9, v9
  v_exp_f32 v10, v10
  v_exp_f32 v11, v11
  v_add_f32 v5, v8, v9
  v_add_f32 v6, v10, v11
  v_add_f32 v3, v3, v5
  v_add_f32 v3, v3, v6
  v_cvt_pk_bf16_f32 v4, v8, v9
  v_cvt_pk_bf16_f32 v5, v10, v11
  s_waitcnt vmcnt(4)
  v_perm_b32 v8, v100, v96, s48
  v_perm_b32 v9, v108, v104, s48
  v_perm_b32 v12, v100, v96, s49
  v_perm_b32 v13, v108, v104, s49
  v_mfma_f32_16x16x16_bf16 v[32:35], v[8:9], v[4:5], v[32:35]
  v_perm_b32 v8, v101, v97, s48
  v_perm_b32 v9, v109, v105, s48
  v_mfma_f32_16x16x16_bf16 v[36:39], v[12:13], v[4:5], v[36:39]
  v_perm_b32 v12, v101, v97, s49
  v_perm_b32 v13, v109, v105, s49
  v_mfma_f32_16x16x16_bf16 v[40:43], v[8:9], v[4:5], v[40:43]
  v_perm_b32 v8, v102, v98, s48
  v_perm_b32 v9, v110, v106, s48
  v_mfma_f32_16x16x16_bf16 v[44:47], v[12:13], v[4:5], v[44:47]
  v_perm_b32 v12, v102, v98, s49
  v_perm_b32 v13, v110, v106, s49
  v_mfma_f32_16x16x16_bf16 v[48:51], v[8:9], v[4:5], v[48:51]
  v_perm_b32 v8, v103, v99, s48
  v_perm_b32 v9, v111, v107, s48
  v_mfma_f32_16x16x16_bf16 v[52:55], v[12:13], v[4:5], v[52:55]
  v_perm_b32 v12, v103, v99, s49
  v_perm_b32 v13, v111, v107, s49
  v_mfma_f32_16x16x16_bf16 v[56:59], v[8:9], v[4:5], v[56:59]
  s_nop 0
  v_mfma_f32_16x16x16_bf16 v[60:63], v[12:13], v[4:5], v[60:63]
  v_mov_b32 v8, 29984
  v_mov_b32 v9, 1
  s_mov_b64 exec, 1
  ds_add_rtn_u32 v10, v8, v9
  s_mov_b64 exec, -1
  buffer_load_dwordx4 v[96:99], v1, s[36:39], s50 offen offset:0 nt
  buffer_load_dwordx4 v[100:103], v1, s[36:39], s50 offen offset:256 nt
  buffer_load_dwordx4 v[104:107], v1, s[36:39], s50 offen offset:512 nt
  buffer_load_dwordx4 v[108:111], v1, s[36:39], s50 offen offset:768 nt
  s_mov_b32 s52, s83
  s_waitcnt lgkmcnt(0)
  v_readfirstlane_b32 s83, v10
  s_nop 0
  s_cmp_lt_u32 s83, 232
  s_cbranch_scc0 L_s_pool
  s_add_u32 s83, s83, s54
L_s_tile:
  s_cmp_lt_u32 s52, 512
  s_nop 3
  s_cbranch_scc1 L_sloop
  s_nop 1
  s_branch L_s_done
L_s_pool:
  s_sub_u32 s83, s83, 232
  s_cmp_lt_u32 s83, 128
  s_nop 0
  s_cbranch_scc1 L_s_pq
  s_mov_b32 s83, 2048
  s_branch L_s_tile
L_s_pq:
  s_lshl_b32 s57, s83, 2
  s_add_u32 s57, s57, 133184
  v_mov_b32 v8, s57
  s_mov_b32 s80, 0
L_s_pqw:
  ds_read_b32 v9, v8
  s_waitcnt lgkmcnt(0)
  v_readfirstlane_b32 s83, v9
  s_nop 0
  s_cmp_lg_u32 s83, -1
  s_cbranch_scc1 L_s_tile
  s_sleep 1
  s_add_u32 s80, s80, 1
  s_cmp_lt_u32 s80, 1048576
  s_nop 0
  s_cbranch_scc1 L_s_pqw
  s_mov_b32 s83, 2048
  s_branch L_s_tile
L_s_done:
  v_mov_b32 v4, v3
  s_nop 1
  v_permlane16_swap_b32 v3, v4
  v_add_f32 v3, v3, v4
  v_mov_b32 v4, v3
  s_nop 1
  v_permlane32_swap_b32 v3, v4
  v_add_f32 v3, v3, v4
  v_mbcnt_lo_u32_b32 v8, -1, 0
  v_mbcnt_hi_u32_b32 v8, -1, v8
  v_and_b32 v9, 15, v8
  v_lshrrev_b32 v10, 4, v8
  s_mul_i32 s57, s3, 1040
  s_add_u32 s57, s57, 17280
  v_lshlrev_b32 v11, 9, v9
  v_lshl_add_u32 v11, v10, 4, v11
  v_add_u32 v11, s57, v11
  v_cmp_gt_u32 vcc, 2, v9
  s_nop 0
  s_and_saveexec_b64 s[68:69], vcc
  ds_write_b128 v11, v[32:35] offset:0
  ds_write_b128 v11, v[36:39] offset:64
  ds_write_b128 v11, v[40:43] offset:128
  ds_write_b128 v11, v[44:47] offset:192
  ds_write_b128 v11, v[48:51] offset:256
  ds_write_b128 v11, v[52:55] offset:320
  ds_write_b128 v11, v[56:59] offset:384
  ds_write_b128 v11, v[60:63] offset:448
  v_cmp_gt_u32 vcc, 2, v8
  s_nop 0
  s_and_b64 exec, exec, vcc
  v_lshlrev_b32 v12, 3, v9
  v_add_u32 v12, s57, v12
  ds_write_b64 v12, v[2:3] offset:1024
  s_mov_b64 exec, s[68:69]
  s_waitcnt vmcnt(0) lgkmcnt(0)
  s_branch L_B4
L_idle:
  s_barrier
  s_cmp_lg_u32 s3, 5
  s_nop 0
  s_cbranch_scc1 L_nofeed
  v_mbcnt_lo_u32_b32 v0, -1, 0
  v_mbcnt_hi_u32_b32 v0, -1, v0
  s_mov_b32 s80, 0
  v_mov_b32 v3, 29984
L_wt_1:
  ds_read_b32 v4, v3
  s_waitcnt lgkmcnt(0)
  v_readfirstlane_b32 s57, v4
  s_nop 0
  s_cmp_ge_u32 s57, 210
  s_nop 0
  s_cbranch_scc1 L_wt_1_done
  s_sleep 32
  s_add_u32 s80, s80, 1
  s_cmp_lt_u32 s80, 65536
  s_nop 0
  s_cbranch_scc1 L_wt_1
L_wt_1_done:
  s_mov_b32 s80, 0
  v_mov_b32 v3, 29980
L_pl_2:
  ds_read_b32 v4, v3
  s_waitcnt lgkmcnt(0)
  v_readfirstlane_b32 s57, v4
  s_nop 0
  s_cmp_ge_u32 s57, 1
  s_nop 0
  s_cbranch_scc1 L_pl_2_done
  s_sleep 16
  s_add_u32 s80, s80, 1
  s_cmp_lt_u32 s80, 262144
  s_nop 0
  s_cbranch_scc1 L_pl_2
L_pl_2_done:
  s_setprio 3
  s_lshl_b32 s61, s29, 4
  s_add_u32 s61, s61, s28
  s_lshl_b32 s61, s61, 6
  s_add_u32 s61, s61, 1257472
  s_mov_b32 s62, 0
  s_mov_b32 s80, 0
  v_mov_b32 v3, 29984
  v_mov_b32 v2, 0
L_fd_loop:
  ds_read_b32 v4, v3
  s_waitcnt lgkmcnt(0)
  v_readfirstlane_b32 s57, v4
  s_nop 0
  s_add_u32 s57, s57, 6
  s_add_u32 s63, s62, 232
  s_cmp_gt_u32 s57, s63
  s_nop 1
  s_cbranch_scc1 L_fd_claim
  s_sleep 2
  s_add_u32 s80, s80, 1
  s_cmp_lt_u32 s80, 2097152
  s_nop 0
  s_cbranch_scc1 L_fd_loop
  s_branch L_fd_rest
L_fd_claim:
  v_mov_b32 v5, 2
  s_mov_b64 exec, 1
  buffer_atomic_add v5, v2, s[44:47], s61 offen sc0 sc1
  s_mov_b64 exec, -1
  s_waitcnt vmcnt(0)
  v_readfirstlane_b32 s57, v5
  s_nop 1
  v_add_u32 v6, s57, v0
  v_add_u32 v7, 232, v6
  v_mov_b32 v8, 2048
  v_cmp_gt_u32 vcc, 48, v6
  s_nop 1
  v_cndmask_b32 v7, v8, v7, vcc
  v_add_u32 v9, s62, v0
  v_lshlrev_b32 v9, 2, v9
  v_add_u32 v9, 133184, v9
  s_mov_b64 exec, 3
  ds_write_b32 v9, v7
  s_mov_b64 exec, -1
  s_add_u32 s62, s62, 2
  s_add_u32 s57, s57, 2
  s_cmp_ge_u32 s57, 48
  s_cbranch_scc1 L_fd_rest
  s_cmp_lt_u32 s62, 126
  s_nop 0
  s_cbranch_scc1 L_fd_loop
L_fd_rest:
  v_mov_b32 v8, 2048
  v_add_u32 v9, s62, v0
  v_cmp_gt_u32 vcc, 128, v9
  v_lshlrev_b32 v9, 2, v9
  v_add_u32 v9, 133184, v9
  s_and_saveexec_b64 s[68:69], vcc
  s_cbranch_execz L_fd_e0
  ds_write_b32 v9, v8
L_fd_e0:
  s_mov_b64 exec, s[68:69]
  v_add_u32 v9, s62, v0
  v_add_u32 v9, 64, v9
  v_cmp_gt_u32 vcc, 128, v9
  v_lshlrev_b32 v9, 2, v9
  v_add_u32 v9, 133184, v9
  s_and_saveexec_b64 s[68:69], vcc
  s_cbranch_execz L_fd_e64
  ds_write_b32 v9, v8
L_fd_e64:
  s_mov_b64 exec, s[68:69]
  s_waitcnt lgkmcnt(0)
  s_setprio 0
  s_branch L_B4
L_nofeed:
  s_cmp_lg_u32 s3, 4
  s_cbranch_scc1 L_nochk
  s_mov_b32 s80, 0
  v_mov_b32 v3, 29984
L_wt_3:
  ds_read_b32 v4, v3
  s_waitcnt lgkmcnt(0)
  v_readfirstlane_b32 s57, v4
  s_nop 0
  s_cmp_ge_u32 s57, 80
  s_nop 0
  s_cbranch_scc1 L_wt_3_done
  s_sleep 32
  s_add_u32 s80, s80, 1
  s_cmp_lt_u32 s80, 65536
  s_nop 0
  s_cbranch_scc1 L_wt_3
L_wt_3_done:
  s_mov_b32 s80, 0
  v_mov_b32 v3, 0
L_pc_4:
  global_load_dword v4, v3, s[24:25] sc1
  s_waitcnt vmcnt(0)
  v_readfirstlane_b32 s57, v4
  s_nop 0
  s_cmp_ge_u32 s57, 256
  s_cbranch_scc1 L_pc_4_done
  s_sleep 32
  s_add_u32 s80, s80, 1
  s_cmp_lt_u32 s80, 65536
  s_nop 0
  s_cbranch_scc1 L_pc_4
L_pc_4_done:
  v_mov_b32 v3, 29980
  v_mov_b32 v4, 1
  s_mov_b64 exec, 1
  ds_write_b32 v3, v4
  s_mov_b64 exec, -1
  s_waitcnt lgkmcnt(0)
L_nochk:
  s_cmp_lt_u32 s3, 6
  s_cbranch_scc1 L_B4
  s_cmp_lt_u32 s31, 10
  s_nop 0
  s_cbranch_scc0 L_rw_hi
  s_cmp_eq_u32 s30, 0
  s_cbranch_scc0 L_B4
  s_mov_b32 s57, s29
  s_nop 0
  s_branch L_rw_go
L_rw_hi:
  s_sub_u32 s57, s31, 5
L_rw_go:
  s_cmp_lt_u32 s57, 9
  s_cbranch_scc0 L_B4
  s_mul_i32 s81, s28, 9
  s_add_u32 s81, s81, s57
  s_lshl_b32 s81, s81, 1
  s_add_u32 s81, s81, s3
  s_sub_u32 s81, s81, 6
  v_mbcnt_lo_u32_b32 v0, -1, 0
  v_mbcnt_hi_u32_b32 v0, -1, v0
  s_mov_b32 s80, 0
  v_mov_b32 v3, 29984
L_wt_5:
  ds_read_b32 v4, v3
  s_waitcnt lgkmcnt(0)
  v_readfirstlane_b32 s57, v4
  s_nop 0
  s_cmp_ge_u32 s57, 200
  s_nop 0
  s_cbranch_scc1 L_wt_5_done
  s_sleep 32
  s_add_u32 s80, s80, 1
  s_cmp_lt_u32 s80, 65536
  s_nop 0
  s_cbranch_scc1 L_wt_5
L_wt_5_done:
  s_mov_b32 s80, 0
  v_mov_b32 v3, 29980
L_pl_6:
  ds_read_b32 v4, v3
  s_waitcnt lgkmcnt(0)
  v_readfirstlane_b32 s57, v4
  s_nop 0
  s_cmp_ge_u32 s57, 1
  s_cbranch_scc1 L_pl_6_done
  s_sleep 16
  s_add_u32 s80, s80, 1
  s_cmp_lt_u32 s80, 262144
  s_nop 0
  s_cbranch_scc1 L_pl_6
L_pl_6_done:
  s_lshr_b32 s82, s81, 6
  s_bfe_u32 s61, s81, 0x30003
  s_and_b32 s62, s81, 7
  s_cmp_lt_u32 s81, 256
  s_cbranch_scc1 L_rp_dec
  s_sub_u32 s63, s81, 256
  s_lshr_b32 s61, s63, 2
  s_and_b32 s62, s63, 3
L_rp_dec:
  s_lshl_b32 s57, s82, 12
  s_lshl_b32 s63, s61, 9
  s_add_u32 s57, s57, s63
  s_lshl_b32 s63, s62, 6
  s_add_u32 s57, s57, s63
  v_and_b32 v2, 15, v0
  s_movk_i32 s63, 20480
  v_mul_lo_u32 v1, v2, s63
  v_lshrrev_b32 v3, 5, v0
  v_bfe_u32 v4, v0, 4, 1
  v_lshl_add_u32 v1, v3, 5, v1
  v_lshl_add_u32 v1, v4, 4, v1
  v_add_u32 v1, s57, v1
  v_and_b32 v6, 3, v0
  s_lshl_b32 s57, s82, 7
  s_lshl_b32 s63, s62, 4
  s_add_u32 s57, s57, s63
  s_add_u32 s57, s57, s61
  v_lshlrev_b32 v3, 3, v3
  v_add_u32 v3, s57, v3
  v_lshl_add_u32 v4, v4, 2, v6
  s_movk_i32 s63, 1152
  v_mul_lo_u32 v4, v4, s63
  v_lshl_add_u32 v7, v3, 1, v4
  s_mov_b32 s76, s4
  s_mov_b32 s77, s5
  s_mov_b32 s78, 9216
  s_mov_b32 s79, 0x20000
  buffer_load_ushort v9, v7, s[76:79], 0 offen
  s_mov_b32 s80, 0
  s_mov_b32 s57, 851968
L_p1_f2:
  buffer_load_dwordx4 v[16:19], v1, s[44:47], s57 offen sc1
  s_waitcnt vmcnt(0)
  v_max3_u32 v5, v16, v17, v18
  v_max_u32 v5, v5, v19
  v_cmp_eq_u32 vcc, -1, v5
  s_nop 1
  s_cbranch_vccz L_p1_f2_done
  s_sleep 32
  s_add_u32 s80, s80, 1
  s_cmp_lt_u32 s80, 262144
  s_cbranch_scc1 L_p1_f2
L_p1_f2_done:
  v_add_f32_dpp v16, v16, v16 quad_perm:[1,0,3,2] row_mask:0xf bank_mask:0xf
  v_add_f32_dpp v17, v17, v17 quad_perm:[1,0,3,2] row_mask:0xf bank_mask:0xf
  v_add_f32_dpp v18, v18, v18 quad_perm:[1,0,3,2] row_mask:0xf bank_mask:0xf
  v_add_f32_dpp v19, v19, v19 quad_perm:[1,0,3,2] row_mask:0xf bank_mask:0xf
  v_add_f32_dpp v16, v16, v16 quad_perm:[2,3,0,1] row_mask:0xf bank_mask:0xf
  v_add_f32_dpp v17, v17, v17 quad_perm:[2,3,0,1] row_mask:0xf bank_mask:0xf
  v_add_f32_dpp v18, v18, v18 quad_perm:[2,3,0,1] row_mask:0xf bank_mask:0xf
  v_add_f32_dpp v19, v19, v19 quad_perm:[2,3,0,1] row_mask:0xf bank_mask:0xf
  v_add_f32_dpp v16, v16, v16 row_half_mirror row_mask:0xf bank_mask:0xf
  v_add_f32_dpp v17, v17, v17 row_half_mirror row_mask:0xf bank_mask:0xf
  v_add_f32_dpp v18, v18, v18 row_half_mirror row_mask:0xf bank_mask:0xf
  v_add_f32_dpp v19, v19, v19 row_half_mirror row_mask:0xf bank_mask:0xf
  v_add_f32_dpp v16, v16, v16 row_mirror row_mask:0xf bank_mask:0xf
  v_add_f32_dpp v17, v17, v17 row_mirror row_mask:0xf bank_mask:0xf
  v_add_f32_dpp v18, v18, v18 row_mirror row_mask:0xf bank_mask:0xf
  v_add_f32_dpp v19, v19, v19 row_mirror row_mask:0xf bank_mask:0xf
  v_mov_b32 v8, v16
  v_cmp_eq_u32 vcc, 1, v6
  s_nop 1
  v_cndmask_b32 v8, v8, v17, vcc
  v_cmp_eq_u32 vcc, 2, v6
  s_nop 1
  v_cndmask_b32 v8, v8, v18, vcc
  v_cmp_eq_u32 vcc, 3, v6
  s_nop 1
  v_cndmask_b32 v8, v8, v19, vcc
  v_cvt_pk_bf16_f32 v8, v8, v8
  v_and_b32 v8, 0xffff0000, v8
  v_lshlrev_b32 v9, 16, v9
  s_branch L_B4
L_aux:
  s_setprio 3
  s_sub_u32 s58, s3, 8
  s_mul_i32 s57, s58, 1152
  s_add_u32 s76, s4, s57
  s_addc_u32 s77, s5, 0
  s_mov_b32 s78, 1152
  s_mov_b32 s79, 0x20000
  v_lshlrev_b32 v4, 4, v0
  buffer_load_dwordx4 v[16:19], v4, s[76:79], 0 offen
  v_lshlrev_b32 v4, 2, v0
  buffer_load_dword v20, v4, s[76:79], 0 offen offset:1024
  s_cmp_lg_u32 s58, 0
  s_cbranch_scc1 L_a_nc
  v_mov_b32 v8, 0
  v_cmp_eq_u32 vcc, 8, v0
  v_mov_b32 v9, 4
  s_nop 0
  v_cndmask_b32 v8, v8, v9, vcc
  v_lshlrev_b32 v9, 2, v0
  v_cmp_gt_u32 vcc, 16, v0
  s_nop 0
  s_and_saveexec_b64 s[68:69], vcc
  ds_write_b32 v9, v8 offset:29952
  s_mov_b64 exec, s[68:69]
  v_mov_b32 v8, -1
  v_add_u32 v9, 133184, v9
  ds_write_b32 v9, v8
  ds_write_b32 v9, v8 offset:256
  s_waitcnt lgkmcnt(0)
L_a_nc:
  s_mov_b32 s59, 0
  s_mov_b32 s60, 0
  s_cmp_lt_u32 s31, 10
  s_cbranch_scc0 L_rd_hi
  s_cmp_eq_u32 s30, 0
  s_cbranch_scc1 L_rd_even
  s_mov_b32 s59, 1
  s_mov_b32 s60, s29
  s_branch L_rd_done
L_rd_even:
  s_lshl_b32 s57, s29, 4
  s_add_u32 s57, s57, s28
  s_cmp_lt_u32 s57, 72
  s_cbranch_scc0 L_rd_red2
  s_mov_b32 s59, 3
  s_mov_b32 s60, s57
  s_branch L_rd_done
L_rd_red2:
  s_branch L_rd_done
L_rd_hi:
  s_cmp_eq_u32 s31, 15
  s_cbranch_scc1 L_rd_red
  s_mov_b32 s59, 2
  s_sub_u32 s60, s31, 10
  s_branch L_rd_done
L_rd_red:
L_rd_done:
  s_mov_b32 s56, 0
  s_sub_u32 s82, s31, 10
  s_cmp_lt_u32 s82, 6
  s_cbranch_scc0 L_a_np
  s_mov_b32 s56, 1
  s_cmp_lt_u32 s58, 6
  s_cbranch_scc0 L_a_w0
  s_mov_b32 s40, s10
  s_mov_b32 s41, s11
  s_mov_b32 s42, 4718592
  s_mov_b32 s43, 0x20000
  v_lshrrev_b32 v3, 4, v0
  v_lshlrev_b32 v3, 16, v3
  v_and_b32 v1, 15, v0
  v_lshl_add_u32 v1, v1, 4, v3
  s_lshr_b32 s61, s82, 1
  s_mul_i32 s61, s61, 6
  s_add_u32 s61, s61, s58
  s_mov_b32 s55, s61
  s_lshl_b32 s54, s61, 18
  s_and_b32 s62, s82, 1
  s_lshl_b32 s62, s62, 8
  s_lshl_b32 s63, s28, 9
  s_add_u32 s54, s54, s62
  s_add_u32 s54, s54, s63
  buffer_load_dwordx4 v[64:67], v1, s[40:43], s54 offen nt
  s_add_u32 s54, s54, 8192
  buffer_load_dwordx4 v[68:71], v1, s[40:43], s54 offen nt
  s_add_u32 s54, s54, 8192
  buffer_load_dwordx4 v[72:75], v1, s[40:43], s54 offen nt
  s_add_u32 s54, s54, 8192
  buffer_load_dwordx4 v[76:79], v1, s[40:43], s54 offen nt
  s_add_u32 s54, s54, 8192
  buffer_load_dwordx4 v[80:83], v1, s[40:43], s54 offen nt
  s_add_u32 s54, s54, 8192
  buffer_load_dwordx4 v[84:87], v1, s[40:43], s54 offen nt
  s_add_u32 s54, s54, 8192
  buffer_load_dwordx4 v[88:91], v1, s[40:43], s54 offen nt
  s_add_u32 s54, s54, 8192
  buffer_load_dwordx4 v[92:95], v1, s[40:43], s54 offen nt
L_a_w8:
  s_barrier
  s_waitcnt vmcnt(8)
  s_nop 1
  s_branch L_a_ln
L_a_np:
  s_cmp_eq_u32 s59, 1
  s_cbranch_scc0 L_a_na
  s_mov_b32 s40, s12
  s_mov_b32 s41, s13
  s_mov_b32 s42, 4718592
  s_mov_b32 s43, 0x20000
  v_lshrrev_b32 v3, 4, v0
  v_and_b32 v4, 1, v3
  v_lshlrev_b32 v4, 6, v4
  v_lshrrev_b32 v3, 1, v3
  v_add_u32 v3, v3, v4
  s_lshl_b32 s57, s28, 8
  s_lshr_b32 s61, s58, 2
  s_lshl_b32 s61, s61, 7
  s_add_u32 s57, s57, s61
  s_and_b32 s61, s58, 3
  s_lshl_b32 s61, s61, 1
  s_add_u32 s57, s57, s61
  s_movk_i32 s53, 9216
  s_movk_i32 s61, 1152
  v_mul_lo_u32 v3, v3, s61
  v_and_b32 v1, 15, v0
  v_lshl_add_u32 v1, v1, 4, v3
  s_mul_i32 s54, s57, 1152
  s_lshl_b32 s61, s60, 8
  s_add_u32 s54, s54, s61
  s_mov_b32 s62, s54
  buffer_load_dwordx4 v[64:67], v1, s[40:43], s62 offen nt
  s_add_u32 s62, s62, s53
  buffer_load_dwordx4 v[68:71], v1, s[40:43], s62 offen nt
  s_add_u32 s62, s62, s53
  buffer_load_dwordx4 v[72:75], v1, s[40:43], s62 offen nt
  s_add_u32 s62, s62, s53
  buffer_load_dwordx4 v[76:79], v1, s[40:43], s62 offen nt
  s_add_u32 s62, s62, s53
  buffer_load_dwordx4 v[80:83], v1, s[40:43], s62 offen nt
  s_add_u32 s62, s62, s53
  buffer_load_dwordx4 v[84:87], v1, s[40:43], s62 offen nt
  s_add_u32 s62, s62, s53
  buffer_load_dwordx4 v[88:91], v1, s[40:43], s62 offen nt
  s_add_u32 s62, s62, s53
  buffer_load_dwordx4 v[92:95], v1, s[40:43], s62 offen nt
  s_branch L_a_w8
L_a_na:
  s_cmp_eq_u32 s59, 3
  s_cbranch_scc0 L_a_w0
  s_mov_b32 s40, s16
  s_mov_b32 s41, s17
  s_mov_b32 s42, 5308416
  s_mov_b32 s43, 0x20000
  s_mov_b32 s72, s18
  s_mov_b32 s73, s19
  s_mov_b32 s74, 5308416
  s_mov_b32 s75, 0x20000
  v_lshrrev_b32 v3, 4, v0
  s_mov_b32 s61, 73728
  v_mul_lo_u32 v3, v3, s61
  v_and_b32 v1, 7, v0
  v_lshl_add_u32 v1, v1, 4, v3
  s_mul_i32 s54, s58, 294912
  s_lshl_b32 s61, s60, 7
  s_add_u32 s54, s54, s61
  s_mov_b32 s62, s54
  s_mov_b32 exec_lo, 0x00ff00ff
  s_mov_b32 exec_hi, 0x00ff00ff
  buffer_load_dwordx4 v[64:67], v1, s[40:43], s62 offen nt
  s_add_u32 s62, s62, 9216
  buffer_load_dwordx4 v[68:71], v1, s[40:43], s62 offen nt
  s_add_u32 s62, s62, 9216
  buffer_load_dwordx4 v[72:75], v1, s[40:43], s62 offen nt
  s_add_u32 s62, s62, 9216
  buffer_load_dwordx4 v[76:79], v1, s[40:43], s62 offen nt
  s_add_u32 s62, s62, 9216
  buffer_load_dwordx4 v[80:83], v1, s[40:43], s62 offen nt
  s_add_u32 s62, s62, 9216
  buffer_load_dwordx4 v[84:87], v1, s[40:43], s62 offen nt
  s_add_u32 s62, s62, 9216
  buffer_load_dwordx4 v[88:91], v1, s[40:43], s62 offen nt
  s_add_u32 s62, s62, 9216
  buffer_load_dwordx4 v[92:95], v1, s[40:43], s62 offen nt
  s_add_u32 s62, s62, 9216
  s_mov_b32 s62, s54
  s_mov_b32 exec_lo, 0xff00ff00
  s_mov_b32 exec_hi, 0xff00ff00
  buffer_load_dwordx4 v[64:67], v1, s[72:75], s62 offen nt
  s_add_u32 s62, s62, 9216
  buffer_load_dwordx4 v[68:71], v1, s[72:75], s62 offen nt
  s_add_u32 s62, s62, 9216
  buffer_load_dwordx4 v[72:75], v1, s[72:75], s62 offen nt
  s_add_u32 s62, s62, 9216
  buffer_load_dwordx4 v[76:79], v1, s[72:75], s62 offen nt
  s_add_u32 s62, s62, 9216
  buffer_load_dwordx4 v[80:83], v1, s[72:75], s62 offen nt
  s_add_u32 s62, s62, 9216
  buffer_load_dwordx4 v[84:87], v1, s[72:75], s62 offen nt
  s_add_u32 s62, s62, 9216
  buffer_load_dwordx4 v[88:91], v1, s[72:75], s62 offen nt
  s_add_u32 s62, s62, 9216
  buffer_load_dwordx4 v[92:95], v1, s[72:75], s62 offen nt
  s_add_u32 s62, s62, 9216
  s_mov_b64 exec, -1
  s_add_u32 s54, s54, 2359296
  s_barrier
  s_waitcnt vmcnt(16)
  s_nop 1
  s_branch L_a_ln
L_a_w0:
  s_barrier
  s_waitcnt vmcnt(0)
L_a_ln:
  s_mul_i32 s63, s58, 1184
  v_lshlrev_b32 v32, 16, v16
  v_and_b32 v33, s66, v16
  v_lshlrev_b32 v34, 16, v17
  v_and_b32 v35, s66, v17
  v_lshlrev_b32 v36, 16, v18
  v_and_b32 v37, s66, v18
  v_lshlrev_b32 v38, 16, v19
  v_and_b32 v39, s66, v19
  v_lshlrev_b32 v40, 16, v20
  v_and_b32 v41, s66, v20
  v_add_f32 v8, v32, v33
  v_add_f32 v8, v8, v34
  v_add_f32 v8, v8, v35
  v_add_f32 v8, v8, v36
  v_add_f32 v8, v8, v37
  v_add_f32 v8, v8, v38
  v_add_f32 v8, v8, v39
  v_add_f32 v8, v8, v40
  v_add_f32 v8, v8, v41
  s_nop 1
  v_add_f32_dpp v8, v8, v8 quad_perm:[1,0,3,2] row_mask:0xf bank_mask:0xf
  s_nop 1
  v_add_f32_dpp v8, v8, v8 quad_perm:[2,3,0,1] row_mask:0xf bank_mask:0xf
  s_nop 1
  v_add_f32_dpp v8, v8, v8 row_half_mirror row_mask:0xf bank_mask:0xf
  s_nop 1
  v_add_f32_dpp v8, v8, v8 row_mirror row_mask:0xf bank_mask:0xf
  v_mov_b32 v9, v8
  s_nop 1
  v_permlane16_swap_b32 v8, v9
  v_add_f32 v8, v8, v9
  v_mov_b32 v9, v8
  s_nop 1
  v_permlane32_swap_b32 v8, v9
  v_add_f32 v8, v8, v9
  s_mov_b32 s61, 0x44100000
  s_mov_b32 s62, 0x3ae38e39
  v_mul_f32 v9, s62, v8
  v_fma_f32 v10, -v9, s61, v8
  v_fma_f32 v9, v10, s62, v9
  v_cmp_gt_u32 vcc, 32, v0
  v_sub_f32 v10, v40, v9
  v_mul_f32 v11, v10, v10
  v_sub_f32 v10, v41, v9
  v_fmac_f32 v11, v10, v10
  v_cndmask_b32 v11, 0, v11, vcc
  v_sub_f32 v10, v32, v9
  v_fmac_f32 v11, v10, v10
  v_sub_f32 v10, v33, v9
  v_fmac_f32 v11, v10, v10
  v_sub_f32 v10, v34, v9
  v_fmac_f32 v11, v10, v10
  v_sub_f32 v10, v35, v9
  v_fmac_f32 v11, v10, v10
  v_sub_f32 v10, v36, v9
  v_fmac_f32 v11, v10, v10
  v_sub_f32 v10, v37, v9
  v_fmac_f32 v11, v10, v10
  v_sub_f32 v10, v38, v9
  v_fmac_f32 v11, v10, v10
  v_sub_f32 v10, v39, v9
  v_fmac_f32 v11, v10, v10
  s_nop 1
  v_add_f32_dpp v11, v11, v11 quad_perm:[1,0,3,2] row_mask:0xf bank_mask:0xf
  s_nop 1
  v_add_f32_dpp v11, v11, v11 quad_perm:[2,3,0,1] row_mask:0xf bank_mask:0xf
  s_nop 1
  v_add_f32_dpp v11, v11, v11 row_half_mirror row_mask:0xf bank_mask:0xf
  s_nop 1
  v_add_f32_dpp v11, v11, v11 row_mirror row_mask:0xf bank_mask:0xf
  v_mov_b32 v10, v11
  s_nop 1
  v_permlane16_swap_b32 v11, v10
  v_add_f32 v11, v11, v10
  v_mov_b32 v10, v11
  s_nop 1
  v_permlane32_swap_b32 v11, v10
  v_add_f32 v11, v11, v10
  v_mul_f32 v10, s62, v11
  v_fma_f32 v8, -v10, s61, v11
  v_fma_f32 v10, v8, s62, v10
  v_cvt_pk_bf16_f32 v9, v9, v9
  v_and_b32 v9, 0xffff0000, v9
  v_cvt_pk_bf16_f32 v10, v10, v10
  v_and_b32 v10, 0xffff0000, v10
  v_add_f32 v10, 0x3727c5ac, v10
  v_cvt_pk_bf16_f32 v10, v10, v10
  v_and_b32 v10, 0xffff0000, v10
  v_sqrt_f32 v11, v10
  s_nop 0
  v_rcp_f32 v8, v11
  v_fma_f32 v12, -v11, v11, v10
  v_mul_f32 v8, 0.5, v8
  v_fma_f32 v11, v12, v8, v11
  v_cvt_pk_bf16_f32 v11, v11, v11
  v_and_b32 v11, 0xffff0000, v11
  v_rcp_f32 v8, v11
  v_sub_f32 v32, v32, v9
  v_sub_f32 v33, v33, v9
  v_sub_f32 v34, v34, v9
  v_sub_f32 v35, v35, v9
  v_sub_f32 v36, v36, v9
  v_sub_f32 v37, v37, v9
  v_sub_f32 v38, v38, v9
  v_sub_f32 v39, v39, v9
  v_sub_f32 v40, v40, v9
  v_sub_f32 v41, v41, v9
  v_cvt_pk_bf16_f32 v16, v32, v33
  v_cvt_pk_bf16_f32 v17, v34, v35
  v_cvt_pk_bf16_f32 v18, v36, v37
  v_cvt_pk_bf16_f32 v19, v38, v39
  v_cvt_pk_bf16_f32 v20, v40, v41
  v_lshlrev_b32 v32, 16, v16
  v_and_b32 v33, s66, v16
  v_lshlrev_b32 v34, 16, v17
  v_and_b32 v35, s66, v17
  v_lshlrev_b32 v36, 16, v18
  v_and_b32 v37, s66, v18
  v_lshlrev_b32 v38, 16, v19
  v_and_b32 v39, s66, v19
  v_lshlrev_b32 v40, 16, v20
  v_and_b32 v41, s66, v20
  v_mul_f32 v12, v32, v8
  v_fma_f32 v13, -v12, v11, v32
  v_fma_f32 v32, v13, v8, v12
  v_mul_f32 v12, v33, v8
  v_fma_f32 v13, -v12, v11, v33
  v_fma_f32 v33, v13, v8, v12
  v_mul_f32 v12, v34, v8
  v_fma_f32 v13, -v12, v11, v34
  v_fma_f32 v34, v13, v8, v12
  v_mul_f32 v12, v35, v8
  v_fma_f32 v13, -v12, v11, v35
  v_fma_f32 v35, v13, v8, v12
  v_mul_f32 v12, v36, v8
  v_fma_f32 v13, -v12, v11, v36
  v_fma_f32 v36, v13, v8, v12
  v_mul_f32 v12, v37, v8
  v_fma_f32 v13, -v12, v11, v37
  v_fma_f32 v37, v13, v8, v12
  v_mul_f32 v12, v38, v8
  v_fma_f32 v13, -v12, v11, v38
  v_fma_f32 v38, v13, v8, v12
  v_mul_f32 v12, v39, v8
  v_fma_f32 v13, -v12, v11, v39
  v_fma_f32 v39, v13, v8, v12
  v_mul_f32 v12, v40, v8
  v_fma_f32 v13, -v12, v11, v40
  v_fma_f32 v40, v13, v8, v12
  v_mul_f32 v12, v41, v8
  v_fma_f32 v13, -v12, v11, v41
  v_fma_f32 v41, v13, v8, v12
  v_cvt_pk_bf16_f32 v16, v32, v33
  v_cvt_pk_bf16_f32 v17, v34, v35
  v_cvt_pk_bf16_f32 v18, v36, v37
  v_cvt_pk_bf16_f32 v19, v38, v39
  v_cvt_pk_bf16_f32 v20, v40, v41
  v_lshlrev_b32 v12, 4, v0
  v_lshlrev_b32 v13, 2, v0
  v_add_u32 v12, s63, v12
  v_add_u32 v13, s63, v13
  ds_write_b128 v12, v[16:19] offset:0
  s_and_saveexec_b64 s[68:69], vcc
  ds_write_b32 v13, v20 offset:1024
  s_mov_b64 exec, s[68:69]
  s_waitcnt lgkmcnt(0)
  v_mov_b32 v3, 29964
  v_mov_b32 v4, 1
  s_mov_b64 exec, 1
  ds_add_u32 v3, v4
  s_mov_b64 exec, -1
  s_mov_b32 s80, 0
L_hs_7:
  ds_read_b32 v4, v3
  s_waitcnt lgkmcnt(0)
  v_readfirstlane_b32 s57, v4
  s_nop 0
  s_cmp_ge_u32 s57, 8
  s_cbranch_scc1 L_hs_7_done
  s_sleep 1
  s_add_u32 s80, s80, 1
  s_cmp_lt_u32 s80, 1048576
  s_nop 0
  s_cbranch_scc1 L_hs_7
L_hs_7_done:
  s_xor_b32 s71, s70, 0x5bd1e995
  s_add_u32 s71, s71, 0x7f4a7c15
  s_add_u32 s70, s70, 0x9e3779b9
  s_cmp_eq_u32 s56, 0
  s_cbranch_scc1 L_a_cons
  s_cmp_lt_u32 s58, 6
  s_nop 0
  s_cbranch_scc0 L_a_pr
  v_and_b32 v2, 7, v0
  s_movk_i32 s57, 1184
  v_mul_lo_u32 v2, v2, s57
  v_lshrrev_b32 v3, 4, v0
  v_lshl_add_u32 v2, v3, 4, v2
  s_lshl_b32 s61, s55, 6
  v_add_u32 v2, s61, v2
  ds_read_b128 v[16:19], v2 offset:0
  s_waitcnt vmcnt(0)
  v_perm_b32 v8, v68, v64, s48
  v_perm_b32 v9, v76, v72, s48
  v_perm_b32 v10, v84, v80, s48
  v_perm_b32 v11, v92, v88, s48
  v_perm_b32 v12, v68, v64, s49
  v_perm_b32 v13, v76, v72, s49
  v_perm_b32 v14, v84, v80, s49
  v_perm_b32 v15, v92, v88, s49
  s_waitcnt lgkmcnt(0)
  v_mfma_f32_16x16x32_bf16 v[32:35], v[8:11], v[16:19], 0
  v_perm_b32 v8, v69, v65, s48
  v_perm_b32 v9, v77, v73, s48
  v_perm_b32 v10, v85, v81, s48
  v_perm_b32 v11, v93, v89, s48
  v_mfma_f32_16x16x32_bf16 v[36:39], v[12:15], v[16:19], 0
  v_perm_b32 v12, v69, v65, s49
  v_perm_b32 v13, v77, v73, s49
  v_perm_b32 v14, v85, v81, s49
  v_perm_b32 v15, v93, v89, s49
  v_mfma_f32_16x16x32_bf16 v[40:43], v[8:11], v[16:19], 0
  v_perm_b32 v8, v70, v66, s48
  v_perm_b32 v9, v78, v74, s48
  v_perm_b32 v10, v86, v82, s48
  v_perm_b32 v11, v94, v90, s48
  v_mfma_f32_16x16x32_bf16 v[44:47], v[12:15], v[16:19], 0
  v_perm_b32 v12, v70, v66, s49
  v_perm_b32 v13, v78, v74, s49
  v_perm_b32 v14, v86, v82, s49
  v_perm_b32 v15, v94, v90, s49
  v_mfma_f32_16x16x32_bf16 v[48:51], v[8:11], v[16:19], 0
  v_perm_b32 v8, v71, v67, s48
  v_perm_b32 v9, v79, v75, s48
  v_perm_b32 v10, v87, v83, s48
  v_perm_b32 v11, v95, v91, s48
  v_mfma_f32_16x16x32_bf16 v[52:55], v[12:15], v[16:19], 0
  v_perm_b32 v12, v71, v67, s49
  v_perm_b32 v13, v79, v75, s49
  v_perm_b32 v14, v87, v83, s49
  v_perm_b32 v15, v95, v91, s49
  v_mfma_f32_16x16x32_bf16 v[56:59], v[8:11], v[16:19], 0
  s_nop 0
  v_mfma_f32_16x16x32_bf16 v[60:63], v[12:15], v[16:19], 0
  v_and_b32 v2, 15, v0
  v_lshlrev_b32 v3, 9, v2
  v_lshrrev_b32 v4, 4, v0
  v_lshl_add_u32 v3, v4, 4, v3
  s_lshl_b32 s61, s58, 12
  s_add_u32 s61, s61, 108608
  v_add_u32 v3, s61, v3
  v_cmp_gt_u32 vcc, 8, v2
  s_nop 0
  s_and_saveexec_b64 s[68:69], vcc
  ds_write_b128 v3, v[32:35] offset:0
  ds_write_b128 v3, v[36:39] offset:64
  ds_write_b128 v3, v[40:43] offset:128
  ds_write_b128 v3, v[44:47] offset:192
  ds_write_b128 v3, v[48:51] offset:256
  ds_write_b128 v3, v[52:55] offset:320
  ds_write_b128 v3, v[56:59] offset:384
  ds_write_b128 v3, v[60:63] offset:448
  s_mov_b64 exec, s[68:69]
L_a_pr:
  s_waitcnt lgkmcnt(0)
  v_mov_b32 v3, 29968
  v_mov_b32 v4, 1
  s_mov_b64 exec, 1
  ds_add_u32 v3, v4
  s_mov_b64 exec, -1
  s_mov_b32 s80, 0
L_hs_8:
  ds_read_b32 v4, v3
  s_waitcnt lgkmcnt(0)
  v_readfirstlane_b32 s57, v4
  s_nop 0
  s_cmp_ge_u32 s57, 8
  s_cbranch_scc1 L_hs_8_done
  s_sleep 1
  s_add_u32 s80, s80, 1
  s_cmp_lt_u32 s80, 1048576
  s_nop 0
  s_cbranch_scc1 L_hs_8
L_hs_8_done:
  s_lshl_b32 s61, s58, 9
  s_add_u32 s61, s61, 108608
  v_lshlrev_b32 v3, 3, v0
  v_add_u32 v3, s61, v3
  ds_read_b64 v[64:65], v3 offset:0
  ds_read_b64 v[66:67], v3 offset:4096
  ds_read_b64 v[68:69], v3 offset:8192
  ds_read_b64 v[70:71], v3 offset:12288
  ds_read_b64 v[72:73], v3 offset:16384
  ds_read_b64 v[74:75], v3 offset:20480
  s_lshr_b32 s57, s82, 1
  s_mul_i32 s61, s28, 3
  s_add_u32 s57, s57, s61
  s_lshl_b32 s57, s57, 3
  s_add_u32 s57, s57, s58
  s_lshl_b32 s57, s57, 11
  s_and_b32 s61, s82, 1
  s_lshl_b32 s61, s61, 10
  s_add_u32 s57, s57, s61
  s_add_u32 s57, s57, 1265664
  v_mov_b32 v10, s70
  v_mov_b32 v11, s71
  v_lshlrev_b32 v3, 4, v0
  s_waitcnt lgkmcnt(0)
  v_add_f32 v64, v64, v66
  v_add_f32 v68, v68, v70
  v_add_f32 v72, v72, v74
  v_add_f32 v64, v64, v68
  v_add_f32 v8, v64, v72
  v_add_f32 v65, v65, v67
  v_add_f32 v69, v69, v71
  v_add_f32 v73, v73, v75
  v_add_f32 v65, v65, v69
  v_add_f32 v9, v65, v73
  buffer_store_dwordx4 v[8:11], v3, s[44:47], s57 offen sc1
L_a_cons:
  s_sub_u32 s63, s58, 2
  s_cmp_lt_u32 s63, 2
  s_cbranch_scc0 L_a_B2
  s_mul_i32 s61, s28, 49152
  s_lshl_b32 s62, s29, 11
  s_add_u32 s61, s61, s62
  s_lshl_b32 s62, s63, 10
  s_add_u32 s61, s61, s62
  s_add_u32 s61, s61, 1265664
  v_lshlrev_b32 v3, 4, v0
  s_mov_b32 s80, 0
L_q_poll:
  s_mov_b32 s57, s61
  buffer_load_dwordx4 v[96:99], v3, s[44:47], s57 offen sc1
  s_add_u32 s57, s57, 16384
  buffer_load_dwordx4 v[100:103], v3, s[44:47], s57 offen sc1
  s_add_u32 s57, s57, 16384
  buffer_load_dwordx4 v[104:107], v3, s[44:47], s57 offen sc1
  s_waitcnt vmcnt(0)
  v_xor_b32 v4, s70, v98
  v_xor_b32 v5, s71, v99
  v_or_b32 v4, v4, v5
  v_xor_b32 v5, s70, v102
  v_xor_b32 v6, s71, v103
  v_or3_b32 v4, v4, v5, v6
  v_xor_b32 v5, s70, v106
  v_xor_b32 v6, s71, v107
  v_or3_b32 v4, v4, v5, v6
  v_cmp_ne_u32 vcc, 0, v4
  s_cbranch_vccz L_q_ok
  s_sleep 8
  s_add_u32 s80, s80, 1
  s_cmp_lt_u32 s80, 262144
  s_cbranch_scc1 L_q_poll
L_q_ok:
  v_add_f32 v96, v96, v100
  v_add_f32 v96, v96, v104
  v_add_f32 v97, v97, v101
  v_add_f32 v97, v97, v105
  v_cvt_pk_bf16_f32 v96, v96, v97
  v_lshrrev_b32 v5, 3, v0
  v_and_b32 v6, 7, v0
  v_lshlrev_b32 v4, 5, v6
  v_lshl_add_u32 v4, v5, 1, v4
  s_lshl_b32 s62, s63, 8
  v_add_u32 v4, s62, v4
  ds_write_b16 v4, v96 offset:16768
  ds_write_b16_d16_hi v4, v96 offset:16784
  s_waitcnt lgkmcnt(0)
  v_mov_b32 v3, 29972
  v_mov_b32 v4, 1
  s_mov_b64 exec, 1
  ds_add_u32 v3, v4
  s_mov_b64 exec, -1
L_a_B2:
  s_cmp_lg_u32 s58, 7
  s_cbranch_scc1 L_reset_done
  v_mov_b32 v4, -1
  v_mov_b32 v5, -1
  v_mov_b32 v6, -1
  v_mov_b32 v7, -1
  v_lshlrev_b32 v3, 4, v0
  s_lshl_b32 s57, s28, 4
  s_add_u32 s57, s57, s31
  s_lshl_b32 s57, s57, 11
  buffer_store_dwordx4 v[4:7], v3, s[44:47], s57 offen sc1
  s_mov_b64 exec, 1
  buffer_store_dwordx4 v[4:7], v3, s[44:47], s57 offen offset:1024 sc1
  s_cmp_lg_u32 s30, 0
  s_cbranch_scc1 L_rs_npm
  s_lshl_b32 s57, s29, 4
  s_add_u32 s57, s57, s28
  s_lshl_b32 s57, s57, 6
  s_add_u32 s57, s57, 1257472
  v_mov_b32 v8, 0
  buffer_store_dword v8, v3, s[44:47], s57 offen sc1
L_rs_npm:
  s_mov_b64 exec, -1
  s_cmp_eq_u32 s59, 0
  s_cbranch_scc1 L_rs_endm
  s_cmp_eq_u32 s59, 3
  s_cbranch_scc1 L_rs_cm
  s_mul_i32 s57, s28, 5
  s_add_u32 s57, s57, s60
  s_lshl_b32 s57, s57, 12
  s_cmp_eq_u32 s59, 1
  s_mov_b32 s62, 851968
  s_cselect_b32 s61, 524288, s62
  s_add_u32 s57, s57, s61
  buffer_store_dwordx4 v[4:7], v3, s[44:47], s57 offen offset:0 sc1
  buffer_store_dwordx4 v[4:7], v3, s[44:47], s57 offen offset:1024 sc1
  buffer_store_dwordx4 v[4:7], v3, s[44:47], s57 offen offset:2048 sc1
  buffer_store_dwordx4 v[4:7], v3, s[44:47], s57 offen offset:3072 sc1
  s_branch L_rs_endm
L_rs_cm:
  v_lshrrev_b32 v8, 3, v0
  s_movk_i32 s61, 9216
  v_mul_lo_u32 v8, v8, s61
  v_and_b32 v9, 7, v0
  v_lshl_add_u32 v8, v9, 4, v8
  s_lshl_b32 s57, s60, 7
  s_add_u32 s57, s57, 1179648
  buffer_store_dwordx4 v[4:7], v8, s[44:47], s57 offen sc1
L_rs_endm:
  s_waitcnt vmcnt(0)
  v_mov_b32 v3, 0
  v_mov_b32 v4, 1
  v_mov_b32 v5, 29976
  s_mov_b64 exec, 1
  global_atomic_add v3, v4, s[24:25] sc1
  ds_add_u32 v5, v4
  s_mov_b64 exec, -1
L_reset_done:
  s_cmp_eq_u32 s59, 3
  s_cbranch_scc1 L_role_c
  s_cmp_eq_u32 s59, 0
  s_cbranch_scc1 L_role_none
  s_mov_b32 s52, s58
  s_cmp_eq_u32 s59, 2
  s_cbranch_scc1 L_wp_b
  s_branch L_wp_fin
L_wp_b:
  s_mov_b32 s40, s20
  s_mov_b32 s41, s21
  s_mov_b32 s42, 5308416
  s_mov_b32 s43, 0x20000
  v_lshrrev_b32 v3, 4, v0
  v_lshlrev_b32 v3, 3, v3
  s_mul_i32 s57, s28, 288
  s_lshl_b32 s61, s58, 5
  s_add_u32 s57, s57, s61
  s_movk_i32 s53, 1152
  s_movk_i32 s61, 1152
  v_mul_lo_u32 v3, v3, s61
  v_and_b32 v1, 15, v0
  v_lshl_add_u32 v1, v1, 4, v3
  s_mul_i32 s54, s57, 1152
  s_lshl_b32 s61, s60, 8
  s_add_u32 s54, s54, s61
L_wp_loop:
  s_mov_b32 s62, s54
  buffer_load_dwordx4 v[64:67], v1, s[40:43], s62 offen nt
  s_add_u32 s62, s62, s53
  buffer_load_dwordx4 v[68:71], v1, s[40:43], s62 offen nt
  s_add_u32 s62, s62, s53
  buffer_load_dwordx4 v[72:75], v1, s[40:43], s62 offen nt
  s_add_u32 s62, s62, s53
  buffer_load_dwordx4 v[76:79], v1, s[40:43], s62 offen nt
  s_add_u32 s62, s62, s53
  buffer_load_dwordx4 v[80:83], v1, s[40:43], s62 offen nt
  s_add_u32 s62, s62, s53
  buffer_load_dwordx4 v[84:87], v1, s[40:43], s62 offen nt
  s_add_u32 s62, s62, s53
  buffer_load_dwordx4 v[88:91], v1, s[40:43], s62 offen nt
  s_add_u32 s62, s62, s53
  buffer_load_dwordx4 v[92:95], v1, s[40:43], s62 offen nt
L_wp_fin:
  s_waitcnt vmcnt(0)
  s_lshl_b32 s57, s52, 13
  v_lshlrev_b32 v3, 4, v0
  v_add_u32 v3, s57, v3
  v_add_u32 v3, 34880, v3
  v_perm_b32 v8, v68, v64, s48
  v_perm_b32 v9, v76, v72, s48
  v_perm_b32 v10, v84, v80, s48
  v_perm_b32 v11, v92, v88, s48
  ds_write_b128 v3, v[8:11] offset:0
  v_perm_b32 v12, v68, v64, s49
  v_perm_b32 v13, v76, v72, s49
  v_perm_b32 v14, v84, v80, s49
  v_perm_b32 v15, v92, v88, s49
  ds_write_b128 v3, v[12:15] offset:1024
  v_perm_b32 v16, v69, v65, s48
  v_perm_b32 v17, v77, v73, s48
  v_perm_b32 v18, v85, v81, s48
  v_perm_b32 v19, v93, v89, s48
  ds_write_b128 v3, v[16:19] offset:2048
  v_perm_b32 v20, v69, v65, s49
  v_perm_b32 v21, v77, v73, s49
  v_perm_b32 v22, v85, v81, s49
  v_perm_b32 v23, v93, v89, s49
  ds_write_b128 v3, v[20:23] offset:3072
  v_perm_b32 v8, v70, v66, s48
  v_perm_b32 v9, v78, v74, s48
  v_perm_b32 v10, v86, v82, s48
  v_perm_b32 v11, v94, v90, s48
  ds_write_b128 v3, v[8:11] offset:4096
  v_perm_b32 v12, v70, v66, s49
  v_perm_b32 v13, v78, v74, s49
  v_perm_b32 v14, v86, v82, s49
  v_perm_b32 v15, v94, v90, s49
  ds_write_b128 v3, v[12:15] offset:5120
  v_perm_b32 v16, v71, v67, s48
  v_perm_b32 v17, v79, v75, s48
  v_perm_b32 v18, v87, v83, s48
  v_perm_b32 v19, v95, v91, s48
  ds_write_b128 v3, v[16:19] offset:6144
  v_perm_b32 v20, v71, v67, s49
  v_perm_b32 v21, v79, v75, s49
  v_perm_b32 v22, v87, v83, s49
  v_perm_b32 v23, v95, v91, s49
  ds_write_b128 v3, v[20:23] offset:7168
  s_cmp_eq_u32 s59, 2
  s_nop 0
  s_cbranch_scc0 L_wp_done
  s_cmp_eq_u32 s52, 0
  s_nop 0
  s_cbranch_scc0 L_wp_done
  s_mov_b32 s52, 8
  s_add_u32 s54, s54, 294912
  s_branch L_wp_loop
L_wp_done:
  s_waitcnt lgkmcnt(0)
  s_cmp_eq_u32 s59, 2
  s_nop 0
  s_cbranch_scc1 L_role_b
  s_cmp_lg_u32 s58, 0
  s_cbranch_scc1 L_mid_done
  s_mov_b32 s80, 0
  v_mov_b32 v3, 29984
L_wt_9:
  ds_read_b32 v4, v3
  s_waitcnt lgkmcnt(0)
  v_readfirstlane_b32 s57, v4
  s_nop 0
  s_cmp_ge_u32 s57, 160
  s_nop 0
  s_cbranch_scc1 L_wt_9_done
  s_sleep 32
  s_add_u32 s80, s80, 1
  s_cmp_lt_u32 s80, 65536
  s_nop 0
  s_cbranch_scc1 L_wt_9
L_wt_9_done:
  s_mov_b32 s80, 0
  v_mov_b32 v3, 29980
L_pl_10:
  ds_read_b32 v4, v3
  s_waitcnt lgkmcnt(0)
  v_readfirstlane_b32 s57, v4
  s_nop 0
  s_cmp_ge_u32 s57, 1
  s_cbranch_scc1 L_pl_10_done
  s_sleep 16
  s_add_u32 s80, s80, 1
  s_cmp_lt_u32 s80, 262144
  s_nop 0
  s_cbranch_scc1 L_pl_10
L_pl_10_done:
  s_branch L_mid_done
L_role_b:
  s_mov_b32 s80, 0
  v_mov_b32 v3, 29984
L_wt_11:
  ds_read_b32 v4, v3
  s_waitcnt lgkmcnt(0)
  v_readfirstlane_b32 s57, v4
  s_nop 0
  s_cmp_ge_u32 s57, 96
  s_nop 0
  s_cbranch_scc1 L_wt_11_done
  s_sleep 32
  s_add_u32 s80, s80, 1
  s_cmp_lt_u32 s80, 65536
  s_nop 0
  s_cbranch_scc1 L_wt_11
L_wt_11_done:
  s_mov_b32 s80, 0
  v_mov_b32 v3, 29980
L_pl_12:
  ds_read_b32 v4, v3
  s_waitcnt lgkmcnt(0)
  v_readfirstlane_b32 s57, v4
  s_nop 0
  s_cmp_ge_u32 s57, 1
  s_nop 0
  s_cbranch_scc1 L_pl_12_done
  s_sleep 16
  s_add_u32 s80, s80, 1
  s_cmp_lt_u32 s80, 262144
  s_nop 0
  s_cbranch_scc1 L_pl_12
L_pl_12_done:
  s_mul_i32 s61, s58, 9216
  s_mul_i32 s62, s28, 576
  s_add_u32 s61, s61, s62
  s_add_u32 s61, s61, 1179648
  v_lshlrev_b32 v5, 4, v0
  v_cmp_gt_u32 vcc, 36, v0
  s_nop 0
  s_and_saveexec_b64 s[68:69], vcc
  s_mov_b32 s80, 0
L_b_poll:
  buffer_load_dwordx4 v[8:11], v5, s[44:47], s61 offen sc1
  s_waitcnt vmcnt(0)
  v_max3_u32 v6, v8, v9, v10
  v_max_u32 v6, v6, v11
  v_cmp_eq_u32 vcc, -1, v6
  s_nop 0
  s_cbranch_vccz L_b_ok
  s_sleep 64
  s_add_u32 s80, s80, 1
  s_cmp_lt_u32 s80, 32768
  s_cbranch_scc1 L_b_poll
L_b_ok:
  s_mul_i32 s61, s58, 608
  v_add_u32 v5, s61, v5
  ds_write_b128 v5, v[8:11] offset:30016
  s_mov_b64 exec, s[68:69]
  s_waitcnt lgkmcnt(0)
  v_mov_b32 v3, 29952
  v_mov_b32 v4, 1
  s_mov_b64 exec, 1
  ds_add_u32 v3, v4
  s_mov_b64 exec, -1
  s_mov_b32 s80, 0
L_hs_13:
  ds_read_b32 v4, v3
  s_waitcnt lgkmcnt(0)
  v_readfirstlane_b32 s57, v4
  s_nop 0
  s_cmp_ge_u32 s57, 8
  s_cbranch_scc1 L_hs_13_done
  s_sleep 1
  s_add_u32 s80, s80, 1
  s_cmp_lt_u32 s80, 1048576
  s_nop 0
  s_cbranch_scc1 L_hs_13
L_hs_13_done:
  s_lshl_b32 s57, s58, 10
  v_lshlrev_b32 v3, 4, v0
  v_add_u32 v3, s57, v3
  v_add_u32 v3, 34880, v3
  ds_read_b128 v[64:67], v3 offset:0
  ds_read_b128 v[68:71], v3 offset:8192
  ds_read_b128 v[72:75], v3 offset:16384
  ds_read_b128 v[76:79], v3 offset:24576
  ds_read_b128 v[80:83], v3 offset:32768
  ds_read_b128 v[84:87], v3 offset:40960
  ds_read_b128 v[88:91], v3 offset:49152
  ds_read_b128 v[92:95], v3 offset:57344
  v_add_u32 v2, 0x10000, v3
  ds_read_b128 v[96:99], v2 offset:0
  v_and_b32 v2, 7, v0
  s_movk_i32 s57, 608
  v_mul_lo_u32 v2, v2, s57
  v_lshrrev_b32 v3, 4, v0
  v_lshl_add_u32 v2, v3, 4, v2
  ds_read_b128 v[4:7], v2 offset:30016
  ds_read_b128 v[8:11], v2 offset:30080
  ds_read_b128 v[12:15], v2 offset:30144
  ds_read_b128 v[16:19], v2 offset:30208
  ds_read_b128 v[20:23], v2 offset:30272
  ds_read_b128 v[24:27], v2 offset:30336
  ds_read_b128 v[28:31], v2 offset:30400
  ds_read_b128 v[100:103], v2 offset:30464
  ds_read_b128 v[104:107], v2 offset:30528
  s_waitcnt lgkmcnt(8)
  v_mfma_f32_16x16x32_bf16 v[32:35], v[4:7], v[64:67], 0
  s_waitcnt lgkmcnt(7)
  v_mfma_f32_16x16x32_bf16 v[32:35], v[8:11], v[68:71], v[32:35]
  s_waitcnt lgkmcnt(6)
  v_mfma_f32_16x16x32_bf16 v[32:35], v[12:15], v[72:75], v[32:35]
  s_waitcnt lgkmcnt(5)
  v_mfma_f32_16x16x32_bf16 v[32:35], v[16:19], v[76:79], v[32:35]
  s_waitcnt lgkmcnt(4)
  v_mfma_f32_16x16x32_bf16 v[32:35], v[20:23], v[80:83], v[32:35]
  s_waitcnt lgkmcnt(3)
  v_mfma_f32_16x16x32_bf16 v[32:35], v[24:27], v[84:87], v[32:35]
  s_waitcnt lgkmcnt(2)
  v_mfma_f32_16x16x32_bf16 v[32:35], v[28:31], v[88:91], v[32:35]
  s_waitcnt lgkmcnt(1)
  v_mfma_f32_16x16x32_bf16 v[32:35], v[100:103], v[92:95], v[32:35]
  s_waitcnt lgkmcnt(0)
  v_mfma_f32_16x16x32_bf16 v[32:35], v[104:107], v[96:99], v[32:35]
  s_mul_i32 s57, s28, 5
  s_add_u32 s57, s57, s60
  s_lshl_b32 s57, s57, 12
  s_lshl_b32 s61, s58, 9
  s_add_u32 s57, s57, s61
  s_add_u32 s57, s57, 851968
  s_nop 1
  v_min_u32 v32, s67, v32
  v_min_u32 v33, s67, v33
  v_min_u32 v34, s67, v34
  v_min_u32 v35, s67, v35
  v_and_b32 v3, 15, v0
  v_lshlrev_b32 v3, 5, v3
  v_lshrrev_b32 v2, 4, v0
  v_lshl_add_u32 v3, v2, 4, v3
  v_cmp_gt_u32 vcc, 32, v0
  s_nop 0
  s_and_saveexec_b64 s[68:69], vcc
  buffer_store_dwordx4 v[32:35], v3, s[44:47], s57 offen sc1
  s_mov_b64 exec, s[68:69]
  s_branch L_mid_done
L_role_c:
  s_mov_b32 s62, s54
  s_mov_b32 exec_lo, 0x00ff00ff
  s_mov_b32 exec_hi, 0x00ff00ff
  buffer_load_dwordx4 v[96:99], v1, s[40:43], s62 offen nt
  s_add_u32 s62, s62, 9216
  buffer_load_dwordx4 v[100:103], v1, s[40:43], s62 offen nt
  s_add_u32 s62, s62, 9216
  buffer_load_dwordx4 v[104:107], v1, s[40:43], s62 offen nt
  s_add_u32 s62, s62, 9216
  buffer_load_dwordx4 v[108:111], v1, s[40:43], s62 offen nt
  s_add_u32 s62, s62, 9216
  buffer_load_dwordx4 v[112:115], v1, s[40:43], s62 offen nt
  s_add_u32 s62, s62, 9216
  buffer_load_dwordx4 v[116:119], v1, s[40:43], s62 offen nt
  s_add_u32 s62, s62, 9216
  buffer_load_dwordx4 v[120:123], v1, s[40:43], s62 offen nt
  s_add_u32 s62, s62, 9216
  buffer_load_dwordx4 v[124:127], v1, s[40:43], s62 offen nt
  s_add_u32 s62, s62, 9216
  s_mov_b32 s62, s54
  s_mov_b32 exec_lo, 0xff00ff00
  s_mov_b32 exec_hi, 0xff00ff00
  buffer_load_dwordx4 v[96:99], v1, s[72:75], s62 offen nt
  s_add_u32 s62, s62, 9216
  buffer_load_dwordx4 v[100:103], v1, s[72:75], s62 offen nt
  s_add_u32 s62, s62, 9216
  buffer_load_dwordx4 v[104:107], v1, s[72:75], s62 offen nt
  s_add_u32 s62, s62, 9216
  buffer_load_dwordx4 v[108:111], v1, s[72:75], s62 offen nt
  s_add_u32 s62, s62, 9216
  buffer_load_dwordx4 v[112:115], v1, s[72:75], s62 offen nt
  s_add_u32 s62, s62, 9216
  buffer_load_dwordx4 v[116:119], v1, s[72:75], s62 offen nt
  s_add_u32 s62, s62, 9216
  buffer_load_dwordx4 v[120:123], v1, s[72:75], s62 offen nt
  s_add_u32 s62, s62, 9216
  buffer_load_dwordx4 v[124:127], v1, s[72:75], s62 offen nt
  s_add_u32 s62, s62, 9216
  s_mov_b64 exec, -1
  s_add_u32 s54, s54, 2359296
  v_and_b32 v2, 7, v0
  s_movk_i32 s57, 1184
  v_mul_lo_u32 v2, v2, s57
  v_lshrrev_b32 v3, 4, v0
  v_lshl_add_u32 v2, v3, 4, v2
  s_lshl_b32 s61, s58, 6
  v_add_u32 v2, s61, v2
  v_mov_b32 v32, 0
  v_mov_b32 v33, 0
  v_mov_b32 v34, 0
  v_mov_b32 v35, 0
  v_mov_b32 v36, 0
  v_mov_b32 v37, 0
  v_mov_b32 v38, 0
  v_mov_b32 v39, 0
  v_mov_b32 v40, 0
  v_mov_b32 v41, 0
  v_mov_b32 v42, 0
  v_mov_b32 v43, 0
  v_mov_b32 v44, 0
  v_mov_b32 v45, 0
  v_mov_b32 v46, 0
  v_mov_b32 v47, 0
  v_mov_b32 v48, 0
  v_mov_b32 v49, 0
  v_mov_b32 v50, 0
  v_mov_b32 v51, 0
  v_mov_b32 v52, 0
  v_mov_b32 v53, 0
  v_mov_b32 v54, 0
  v_mov_b32 v55, 0
  v_mov_b32 v56, 0
  v_mov_b32 v57, 0
  v_mov_b32 v58, 0
  v_mov_b32 v59, 0
  v_mov_b32 v60, 0
  v_mov_b32 v61, 0
  v_mov_b32 v62, 0
  v_mov_b32 v63, 0
  ds_read_b128 v[16:19], v2 offset:0
  s_waitcnt vmcnt(16)
  v_perm_b32 v8, v68, v64, s48
  v_perm_b32 v9, v76, v72, s48
  v_perm_b32 v10, v84, v80, s48
  v_perm_b32 v11, v92, v88, s48
  v_perm_b32 v12, v68, v64, s49
  v_perm_b32 v13, v76, v72, s49
  v_perm_b32 v14, v84, v80, s49
  v_perm_b32 v15, v92, v88, s49
  s_waitcnt lgkmcnt(0)
  v_mfma_f32_16x16x32_bf16 v[32:35], v[16:19], v[8:11], v[32:35]
  v_perm_b32 v8, v69, v65, s48
  v_perm_b32 v9, v77, v73, s48
  v_perm_b32 v10, v85, v81, s48
  v_perm_b32 v11, v93, v89, s48
  v_mfma_f32_16x16x32_bf16 v[36:39], v[16:19], v[12:15], v[36:39]
  v_perm_b32 v12, v69, v65, s49
  v_perm_b32 v13, v77, v73, s49
  v_perm_b32 v14, v85, v81, s49
  v_perm_b32 v15, v93, v89, s49
  v_mfma_f32_16x16x32_bf16 v[40:43], v[16:19], v[8:11], v[40:43]
  v_perm_b32 v8, v70, v66, s48
  v_perm_b32 v9, v78, v74, s48
  v_perm_b32 v10, v86, v82, s48
  v_perm_b32 v11, v94, v90, s48
  v_mfma_f32_16x16x32_bf16 v[44:47], v[16:19], v[12:15], v[44:47]
  v_perm_b32 v12, v70, v66, s49
  v_perm_b32 v13, v78, v74, s49
  v_perm_b32 v14, v86, v82, s49
  v_perm_b32 v15, v94, v90, s49
  v_mfma_f32_16x16x32_bf16 v[48:51], v[16:19], v[8:11], v[48:51]
  v_perm_b32 v8, v71, v67, s48
  v_perm_b32 v9, v79, v75, s48
  v_perm_b32 v10, v87, v83, s48
  v_perm_b32 v11, v95, v91, s48
  v_mfma_f32_16x16x32_bf16 v[52:55], v[16:19], v[12:15], v[52:55]
  v_perm_b32 v12, v71, v67, s49
  v_perm_b32 v13, v79, v75, s49
  v_perm_b32 v14, v87, v83, s49
  v_perm_b32 v15, v95, v91, s49
  v_mfma_f32_16x16x32_bf16 v[56:59], v[16:19], v[8:11], v[56:59]
  s_nop 0
  v_mfma_f32_16x16x32_bf16 v[60:63], v[16:19], v[12:15], v[60:63]
  s_cmp_ge_u32 s58, 2
  s_cbranch_scc1 L_c_u1
  s_mov_b32 s62, s54
  s_mov_b32 exec_lo, 0x00ff00ff
  s_mov_b32 exec_hi, 0x00ff00ff
  buffer_load_dwordx4 v[64:67], v1, s[40:43], s62 offen nt
  s_add_u32 s62, s62, 9216
  buffer_load_dwordx4 v[68:71], v1, s[40:43], s62 offen nt
  s_add_u32 s62, s62, 9216
  buffer_load_dwordx4 v[72:75], v1, s[40:43], s62 offen nt
  s_add_u32 s62, s62, 9216
  buffer_load_dwordx4 v[76:79], v1, s[40:43], s62 offen nt
  s_add_u32 s62, s62, 9216
  buffer_load_dwordx4 v[80:83], v1, s[40:43], s62 offen nt
  s_add_u32 s62, s62, 9216
  buffer_load_dwordx4 v[84:87], v1, s[40:43], s62 offen nt
  s_add_u32 s62, s62, 9216
  buffer_load_dwordx4 v[88:91], v1, s[40:43], s62 offen nt
  s_add_u32 s62, s62, 9216
  buffer_load_dwordx4 v[92:95], v1, s[40:43], s62 offen nt
  s_add_u32 s62, s62, 9216
  s_mov_b32 s62, s54
  s_mov_b32 exec_lo, 0xff00ff00
  s_mov_b32 exec_hi, 0xff00ff00
  buffer_load_dwordx4 v[64:67], v1, s[72:75], s62 offen nt
  s_add_u32 s62, s62, 9216
  buffer_load_dwordx4 v[68:71], v1, s[72:75], s62 offen nt
  s_add_u32 s62, s62, 9216
  buffer_load_dwordx4 v[72:75], v1, s[72:75], s62 offen nt
  s_add_u32 s62, s62, 9216
  buffer_load_dwordx4 v[76:79], v1, s[72:75], s62 offen nt
  s_add_u32 s62, s62, 9216
  buffer_load_dwordx4 v[80:83], v1, s[72:75], s62 offen nt
  s_add_u32 s62, s62, 9216
  buffer_load_dwordx4 v[84:87], v1, s[72:75], s62 offen nt
  s_add_u32 s62, s62, 9216
  buffer_load_dwordx4 v[88:91], v1, s[72:75], s62 offen nt
  s_add_u32 s62, s62, 9216
  buffer_load_dwordx4 v[92:95], v1, s[72:75], s62 offen nt
  s_add_u32 s62, s62, 9216
  s_mov_b64 exec, -1
  s_add_u32 s54, s54, 2359296
  ds_read_b128 v[16:19], v2 offset:512
  s_waitcnt vmcnt(16)
  v_perm_b32 v8, v100, v96, s48
  v_perm_b32 v9, v108, v104, s48
  v_perm_b32 v10, v116, v112, s48
  v_perm_b32 v11, v124, v120, s48
  v_perm_b32 v12, v100, v96, s49
  v_perm_b32 v13, v108, v104, s49
  v_perm_b32 v14, v116, v112, s49
  v_perm_b32 v15, v124, v120, s49
  s_waitcnt lgkmcnt(0)
  v_mfma_f32_16x16x32_bf16 v[32:35], v[16:19], v[8:11], v[32:35]
  v_perm_b32 v8, v101, v97, s48
  v_perm_b32 v9, v109, v105, s48
  v_perm_b32 v10, v117, v113, s48
  v_perm_b32 v11, v125, v121, s48
  v_mfma_f32_16x16x32_bf16 v[36:39], v[16:19], v[12:15], v[36:39]
  v_perm_b32 v12, v101, v97, s49
  v_perm_b32 v13, v109, v105, s49
  v_perm_b32 v14, v117, v113, s49
  v_perm_b32 v15, v125, v121, s49
  v_mfma_f32_16x16x32_bf16 v[40:43], v[16:19], v[8:11], v[40:43]
  v_perm_b32 v8, v102, v98, s48
  v_perm_b32 v9, v110, v106, s48
  v_perm_b32 v10, v118, v114, s48
  v_perm_b32 v11, v126, v122, s48
  v_mfma_f32_16x16x32_bf16 v[44:47], v[16:19], v[12:15], v[44:47]
  v_perm_b32 v12, v102, v98, s49
  v_perm_b32 v13, v110, v106, s49
  v_perm_b32 v14, v118, v114, s49
  v_perm_b32 v15, v126, v122, s49
  v_mfma_f32_16x16x32_bf16 v[48:51], v[16:19], v[8:11], v[48:51]
  v_perm_b32 v8, v103, v99, s48
  v_perm_b32 v9, v111, v107, s48
  v_perm_b32 v10, v119, v115, s48
  v_perm_b32 v11, v127, v123, s48
  v_mfma_f32_16x16x32_bf16 v[52:55], v[16:19], v[12:15], v[52:55]
  v_perm_b32 v12, v103, v99, s49
  v_perm_b32 v13, v111, v107, s49
  v_perm_b32 v14, v119, v115, s49
  v_perm_b32 v15, v127, v123, s49
  v_mfma_f32_16x16x32_bf16 v[56:59], v[16:19], v[8:11], v[56:59]
  s_nop 0
  v_mfma_f32_16x16x32_bf16 v[60:63], v[16:19], v[12:15], v[60:63]
  ds_read_b128 v[16:19], v2 offset:1024
  s_waitcnt vmcnt(0)
  v_perm_b32 v8, v68, v64, s48
  v_perm_b32 v9, v76, v72, s48
  v_perm_b32 v10, v84, v80, s48
  v_perm_b32 v11, v92, v88, s48
  v_perm_b32 v12, v68, v64, s49
  v_perm_b32 v13, v76, v72, s49
  v_perm_b32 v14, v84, v80, s49
  v_perm_b32 v15, v92, v88, s49
  s_waitcnt lgkmcnt(0)
  v_mfma_f32_16x16x32_bf16 v[32:35], v[16:19], v[8:11], v[32:35]
  v_perm_b32 v8, v69, v65, s48
  v_perm_b32 v9, v77, v73, s48
  v_perm_b32 v10, v85, v81, s48
  v_perm_b32 v11, v93, v89, s48
  v_mfma_f32_16x16x32_bf16 v[36:39], v[16:19], v[12:15], v[36:39]
  v_perm_b32 v12, v69, v65, s49
  v_perm_b32 v13, v77, v73, s49
  v_perm_b32 v14, v85, v81, s49
  v_perm_b32 v15, v93, v89, s49
  v_mfma_f32_16x16x32_bf16 v[40:43], v[16:19], v[8:11], v[40:43]
  v_perm_b32 v8, v70, v66, s48
  v_perm_b32 v9, v78, v74, s48
  v_perm_b32 v10, v86, v82, s48
  v_perm_b32 v11, v94, v90, s48
  v_mfma_f32_16x16x32_bf16 v[44:47], v[16:19], v[12:15], v[44:47]
  v_perm_b32 v12, v70, v66, s49
  v_perm_b32 v13, v78, v74, s49
  v_perm_b32 v14, v86, v82, s49
  v_perm_b32 v15, v94, v90, s49
  v_mfma_f32_16x16x32_bf16 v[48:51], v[16:19], v[8:11], v[48:51]
  v_perm_b32 v8, v71, v67, s48
  v_perm_b32 v9, v79, v75, s48
  v_perm_b32 v10, v87, v83, s48
  v_perm_b32 v11, v95, v91, s48
  v_mfma_f32_16x16x32_bf16 v[52:55], v[16:19], v[12:15], v[52:55]
  v_perm_b32 v12, v71, v67, s49
  v_perm_b32 v13, v79, v75, s49
  v_perm_b32 v14, v87, v83, s49
  v_perm_b32 v15, v95, v91, s49
  v_mfma_f32_16x16x32_bf16 v[56:59], v[16:19], v[8:11], v[56:59]
  s_nop 0
  v_mfma_f32_16x16x32_bf16 v[60:63], v[16:19], v[12:15], v[60:63]
  s_nop 0
  s_branch L_c_ud
L_c_u1:
  ds_read_b128 v[16:19], v2 offset:512
  s_waitcnt vmcnt(0)
  v_perm_b32 v8, v100, v96, s48
  v_perm_b32 v9, v108, v104, s48
  v_perm_b32 v10, v116, v112, s48
  v_perm_b32 v11, v124, v120, s48
  v_perm_b32 v12, v100, v96, s49
  v_perm_b32 v13, v108, v104, s49
  v_perm_b32 v14, v116, v112, s49
  v_perm_b32 v15, v124, v120, s49
  s_waitcnt lgkmcnt(0)
  v_mfma_f32_16x16x32_bf16 v[32:35], v[16:19], v[8:11], v[32:35]
  v_perm_b32 v8, v101, v97, s48
  v_perm_b32 v9, v109, v105, s48
  v_perm_b32 v10, v117, v113, s48
  v_perm_b32 v11, v125, v121, s48
  v_mfma_f32_16x16x32_bf16 v[36:39], v[16:19], v[12:15], v[36:39]
  v_perm_b32 v12, v101, v97, s49
  v_perm_b32 v13, v109, v105, s49
  v_perm_b32 v14, v117, v113, s49
  v_perm_b32 v15, v125, v121, s49
  v_mfma_f32_16x16x32_bf16 v[40:43], v[16:19], v[8:11], v[40:43]
  v_perm_b32 v8, v102, v98, s48
  v_perm_b32 v9, v110, v106, s48
  v_perm_b32 v10, v118, v114, s48
  v_perm_b32 v11, v126, v122, s48
  v_mfma_f32_16x16x32_bf16 v[44:47], v[16:19], v[12:15], v[44:47]
  v_perm_b32 v12, v102, v98, s49
  v_perm_b32 v13, v110, v106, s49
  v_perm_b32 v14, v118, v114, s49
  v_perm_b32 v15, v126, v122, s49
  v_mfma_f32_16x16x32_bf16 v[48:51], v[16:19], v[8:11], v[48:51]
  v_perm_b32 v8, v103, v99, s48
  v_perm_b32 v9, v111, v107, s48
  v_perm_b32 v10, v119, v115, s48
  v_perm_b32 v11, v127, v123, s48
  v_mfma_f32_16x16x32_bf16 v[52:55], v[16:19], v[12:15], v[52:55]
  v_perm_b32 v12, v103, v99, s49
  v_perm_b32 v13, v111, v107, s49
  v_perm_b32 v14, v119, v115, s49
  v_perm_b32 v15, v127, v123, s49
  v_mfma_f32_16x16x32_bf16 v[56:59], v[16:19], v[8:11], v[56:59]
  s_nop 0
  v_mfma_f32_16x16x32_bf16 v[60:63], v[16:19], v[12:15], v[60:63]
L_c_ud:
  s_lshl_b32 s57, s58, 12
  v_and_b32 v3, 15, v0
  v_lshlrev_b32 v3, 8, v3
  v_lshrrev_b32 v4, 4, v0
  v_lshl_add_u32 v3, v4, 4, v3
  v_add_u32 v3, s57, v3
  v_cmp_gt_u32 vcc, 32, v0
  s_nop 0
  s_and_saveexec_b64 s[68:69], vcc
  ds_write_b128 v3, v[32:35] offset:34880
  ds_write_b128 v3, v[36:39] offset:34912
  ds_write_b128 v3, v[40:43] offset:34944
  ds_write_b128 v3, v[44:47] offset:34976
  ds_write_b128 v3, v[48:51] offset:35008
  ds_write_b128 v3, v[52:55] offset:35040
  ds_write_b128 v3, v[56:59] offset:35072
  ds_write_b128 v3, v[60:63] offset:35104
  s_mov_b64 exec, s[68:69]
  s_waitcnt lgkmcnt(0)
  v_mov_b32 v3, 29956
  v_mov_b32 v4, 1
  s_mov_b64 exec, 1
  ds_add_u32 v3, v4
  s_mov_b64 exec, -1
  s_mov_b32 s80, 0
L_hs_14:
  ds_read_b32 v4, v3
  s_waitcnt lgkmcnt(0)
  v_readfirstlane_b32 s57, v4
  s_nop 0
  s_cmp_ge_u32 s57, 8
  s_cbranch_scc1 L_hs_14_done
  s_sleep 1
  s_add_u32 s80, s80, 1
  s_cmp_lt_u32 s80, 1048576
  s_nop 0
  s_cbranch_scc1 L_hs_14
L_hs_14_done:
  s_lshl_b32 s57, s58, 6
  v_add_u32 v3, s57, v0
  v_lshlrev_b32 v4, 2, v3
  v_add_u32 v4, 34880, v4
  ds_read_b32 v8, v4 offset:0
  ds_read_b32 v9, v4 offset:4096
  ds_read_b32 v10, v4 offset:8192
  ds_read_b32 v11, v4 offset:12288
  ds_read_b32 v12, v4 offset:16384
  ds_read_b32 v13, v4 offset:20480
  ds_read_b32 v14, v4 offset:24576
  ds_read_b32 v15, v4 offset:28672
  ds_read_b32 v16, v4 offset:2048
  ds_read_b32 v17, v4 offset:6144
  ds_read_b32 v18, v4 offset:10240
  ds_read_b32 v19, v4 offset:14336
  ds_read_b32 v20, v4 offset:18432
  ds_read_b32 v21, v4 offset:22528
  ds_read_b32 v22, v4 offset:26624
  ds_read_b32 v23, v4 offset:30720
  s_waitcnt lgkmcnt(0)
  v_add_f32 v8, v8, v12
  v_add_f32 v9, v9, v13
  v_add_f32 v10, v10, v14
  v_add_f32 v11, v11, v15
  v_add_f32 v8, v8, v10
  v_add_f32 v9, v9, v11
  v_add_f32 v8, v8, v9
  v_cvt_pk_bf16_f32 v8, v8, v8
  v_and_b32 v8, 0xffff0000, v8
  v_add_f32 v16, v16, v20
  v_add_f32 v17, v17, v21
  v_add_f32 v18, v18, v22
  v_add_f32 v19, v19, v23
  v_add_f32 v16, v16, v18
  v_add_f32 v17, v17, v19
  v_add_f32 v16, v16, v17
  v_cvt_pk_bf16_f32 v16, v16, v16
  v_and_b32 v16, 0xffff0000, v16
  v_mul_f32 v10, s64, v8
  v_exp_f32 v10, -v10
  s_nop 0
  v_add_f32 v10, 1.0, v10
  v_rcp_f32 v12, v10
  s_nop 0
  v_mul_f32 v14, v8, v12
  v_fma_f32 v18, -v14, v10, v8
  v_fma_f32 v14, v18, v12, v14
  v_cvt_pk_bf16_f32 v14, v14, v14
  v_and_b32 v14, 0xffff0000, v14
  v_mul_f32 v14, v14, v16
  v_cvt_pk_bf16_f32 v14, v14, v14
  v_lshrrev_b32 v5, 3, v3
  v_and_b32 v6, 7, v3
  v_lshlrev_b32 v6, 7, v6
  v_lshl_add_u32 v6, v5, 1, v6
  ds_write_b16 v6, v14 offset:30016
  s_waitcnt lgkmcnt(0)
  v_mov_b32 v3, 29960
  v_mov_b32 v4, 1
  s_mov_b64 exec, 1
  ds_add_u32 v3, v4
  s_mov_b64 exec, -1
  s_mov_b32 s80, 0
L_hs_15:
  ds_read_b32 v4, v3
  s_waitcnt lgkmcnt(0)
  v_readfirstlane_b32 s57, v4
  s_nop 0
  s_cmp_ge_u32 s57, 8
  s_nop 0
  s_cbranch_scc1 L_hs_15_done
  s_sleep 1
  s_add_u32 s80, s80, 1
  s_cmp_lt_u32 s80, 1048576
  s_nop 0
  s_cbranch_scc1 L_hs_15
L_hs_15_done:
  s_cmp_lg_u32 s58, 0
  s_cbranch_scc1 L_c_done
  v_mov_b32 v3, 29976
  s_mov_b32 s80, 0
L_c_rw:
  ds_read_b32 v4, v3
  s_waitcnt lgkmcnt(0)
  v_readfirstlane_b32 s57, v4
  s_nop 0
  s_cmp_ge_u32 s57, 1
  s_cbranch_scc1 L_c_rok
  s_sleep 4
  s_add_u32 s80, s80, 1
  s_cmp_lt_u32 s80, 1048576
  s_nop 0
  s_cbranch_scc1 L_c_rw
L_c_rok:
  v_lshlrev_b32 v3, 4, v0
  ds_read_b128 v[4:7], v3 offset:30016
  v_lshrrev_b32 v8, 3, v0
  s_movk_i32 s61, 9216
  v_mul_lo_u32 v8, v8, s61
  v_and_b32 v9, 7, v0
  v_lshl_add_u32 v8, v9, 4, v8
  s_lshl_b32 s57, s60, 7
  s_add_u32 s57, s57, 1179648
  s_waitcnt lgkmcnt(0)
  v_min_u32 v4, s67, v4
  v_min_u32 v5, s67, v5
  v_min_u32 v6, s67, v6
  v_min_u32 v7, s67, v7
  buffer_store_dwordx4 v[4:7], v8, s[44:47], s57 offen sc1
L_c_done:
  s_branch L_mid_done
L_role_none:
L_mid_done:
  s_branch L_B4
L_B4:
  s_barrier
  s_setprio 0
  v_mbcnt_lo_u32_b32 v0, -1, 0
  v_mbcnt_hi_u32_b32 v0, -1, v0
  s_cmp_lg_u32 s3, 0
  s_cbranch_scc1 L_nomerge
  v_lshlrev_b32 v2, 4, v0
  v_lshrrev_b32 v3, 5, v0
  v_lshlrev_b32 v3, 3, v3
  ds_read_b64 v[16:17], v3 offset:18304
  ds_read_b64 v[18:19], v3 offset:19344
  ds_read_b64 v[20:21], v3 offset:20384
  ds_read_b64 v[22:23], v3 offset:21424
  ds_read_b128 v[32:35], v2 offset:17280
  ds_read_b128 v[36:39], v2 offset:18320
  ds_read_b128 v[40:43], v2 offset:19360
  ds_read_b128 v[44:47], v2 offset:20400
  s_waitcnt lgkmcnt(4)
  v_max_f32 v4, v16, v18
  v_max_f32 v4, v4, v20
  v_max_f32 v4, v4, v22
  v_sub_f32 v16, v16, v4
  v_mul_f32 v16, s64, v16
  v_exp_f32 v16, v16
  v_sub_f32 v18, v18, v4
  v_mul_f32 v18, s64, v18
  v_exp_f32 v18, v18
  v_sub_f32 v20, v20, v4
  v_mul_f32 v20, s64, v20
  v_exp_f32 v20, v20
  v_sub_f32 v22, v22, v4
  v_mul_f32 v22, s64, v22
  v_exp_f32 v22, v22
  v_mul_f32 v5, v16, v17
  v_fmac_f32 v5, v18, v19
  v_fmac_f32 v5, v20, v21
  v_fmac_f32 v5, v22, v23
  s_waitcnt lgkmcnt(0)
  v_mul_f32 v8, v16, v32
  v_mul_f32 v9, v16, v33
  v_mul_f32 v10, v16, v34
  v_mul_f32 v11, v16, v35
  v_fmac_f32 v8, v18, v36
  v_fmac_f32 v9, v18, v37
  v_fmac_f32 v10, v18, v38
  v_fmac_f32 v11, v18, v39
  v_fmac_f32 v8, v20, v40
  v_fmac_f32 v9, v20, v41
  v_fmac_f32 v10, v20, v42
  v_fmac_f32 v11, v20, v43
  v_fmac_f32 v8, v22, v44
  v_fmac_f32 v9, v22, v45
  v_fmac_f32 v10, v22, v46
  v_fmac_f32 v11, v22, v47
  v_min_u32 v8, s67, v8
  v_min_u32 v9, s67, v9
  v_min_u32 v10, s67, v10
  v_min_u32 v11, s67, v11
  v_min_u32 v4, s67, v4
  v_min_u32 v5, s67, v5
  s_lshl_b32 s57, s28, 4
  s_add_u32 s57, s57, s31
  s_lshl_b32 s57, s57, 11
  buffer_store_dwordx4 v[8:11], v2, s[44:47], s57 offen sc1
  v_readlane_b32 s61, v4, 32
  v_readlane_b32 s62, v5, 32
  v_mov_b32 v12, v4
  v_mov_b32 v13, v5
  v_mov_b32 v14, s61
  v_mov_b32 v15, s62
  v_mov_b32 v3, 0
  s_mov_b64 exec, 1
  buffer_store_dwordx4 v[12:15], v3, s[44:47], s57 offen offset:1024 sc1
  s_mov_b64 exec, -1
L_nomerge:
  s_cmp_lt_u32 s31, 10
  s_cbranch_scc0 L_notcons
  s_cmp_eq_u32 s30, 1
  s_cbranch_scc1 L_consumer
L_notcons:
  s_cmp_lt_i32 s81, 0
  s_cbranch_scc1 L_end
  s_setprio 3
  s_mov_b32 s80, 0
  s_mov_b32 s57, 524288
L_p1_p2:
  buffer_load_dwordx4 v[16:19], v1, s[44:47], s57 offen sc1
  s_waitcnt vmcnt(0)
  v_max3_u32 v5, v16, v17, v18
  v_max_u32 v5, v5, v19
  v_cmp_eq_u32 vcc, -1, v5
  s_nop 1
  s_cbranch_vccz L_p1_p2_done
  s_sleep 1
  s_add_u32 s80, s80, 1
  s_cmp_lt_u32 s80, 262144
  s_cbranch_scc1 L_p1_p2
L_p1_p2_done:
  v_add_f32_dpp v16, v16, v16 quad_perm:[1,0,3,2] row_mask:0xf bank_mask:0xf
  v_add_f32_dpp v17, v17, v17 quad_perm:[1,0,3,2] row_mask:0xf bank_mask:0xf
  v_add_f32_dpp v18, v18, v18 quad_perm:[1,0,3,2] row_mask:0xf bank_mask:0xf
  v_add_f32_dpp v19, v19, v19 quad_perm:[1,0,3,2] row_mask:0xf bank_mask:0xf
  v_add_f32_dpp v16, v16, v16 quad_perm:[2,3,0,1] row_mask:0xf bank_mask:0xf
  v_add_f32_dpp v17, v17, v17 quad_perm:[2,3,0,1] row_mask:0xf bank_mask:0xf
  v_add_f32_dpp v18, v18, v18 quad_perm:[2,3,0,1] row_mask:0xf bank_mask:0xf
  v_add_f32_dpp v19, v19, v19 quad_perm:[2,3,0,1] row_mask:0xf bank_mask:0xf
  v_add_f32_dpp v16, v16, v16 row_half_mirror row_mask:0xf bank_mask:0xf
  v_add_f32_dpp v17, v17, v17 row_half_mirror row_mask:0xf bank_mask:0xf
  v_add_f32_dpp v18, v18, v18 row_half_mirror row_mask:0xf bank_mask:0xf
  v_add_f32_dpp v19, v19, v19 row_half_mirror row_mask:0xf bank_mask:0xf
  v_add_f32_dpp v16, v16, v16 row_mirror row_mask:0xf bank_mask:0xf
  v_add_f32_dpp v17, v17, v17 row_mirror row_mask:0xf bank_mask:0xf
  v_add_f32_dpp v18, v18, v18 row_mirror row_mask:0xf bank_mask:0xf
  v_add_f32_dpp v19, v19, v19 row_mirror row_mask:0xf bank_mask:0xf
  v_mov_b32 v10, v16
  v_cmp_eq_u32 vcc, 1, v6
  s_nop 1
  v_cndmask_b32 v10, v10, v17, vcc
  v_cmp_eq_u32 vcc, 2, v6
  s_nop 1
  v_cndmask_b32 v10, v10, v18, vcc
  v_cmp_eq_u32 vcc, 3, v6
  s_nop 1
  v_cndmask_b32 v10, v10, v19, vcc
  v_cvt_pk_bf16_f32 v10, v10, v10
  v_and_b32 v10, 0xffff0000, v10
  v_add_f32 v10, v9, v10
  v_cvt_pk_bf16_f32 v10, v10, v10
  v_and_b32 v10, 0xffff0000, v10
  v_add_f32 v10, v10, v8
  v_cvt_pk_bf16_f32 v10, v10, v10
  s_mov_b32 s76, s22
  s_mov_b32 s77, s23
  s_mov_b32 s78, 9216
  s_mov_b32 s79, 0x20000
  v_and_b32 v2, 15, v0
  v_cmp_gt_u32 vcc, 4, v2
  s_nop 0
  s_and_saveexec_b64 s[68:69], vcc
  buffer_store_short v10, v7, s[76:79], 0 offen
  s_mov_b64 exec, s[68:69]
  s_cmp_lg_u32 s81, 0
  s_cbranch_scc1 L_end
  s_add_u32 s70, s70, 0x9e3779b9
  v_mov_b32 v3, s70
  v_mov_b32 v2, 0
  s_mov_b32 s57, 1253376
  s_mov_b64 exec, 1
  buffer_store_dword v3, v2, s[44:47], s57 offen sc1
  s_mov_b64 exec, -1
  s_branch L_end
L_consumer:
  s_cmp_ge_u32 s3, 8
  s_cbranch_scc1 L_c_nopre
  s_lshl_b32 s57, s3, 10
  v_lshlrev_b32 v3, 4, v0
  v_add_u32 v3, s57, v3
  v_add_u32 v3, 34880, v3
  ds_read_b128 v[64:67], v3 offset:0
  ds_read_b128 v[68:71], v3 offset:8192
  ds_read_b128 v[72:75], v3 offset:16384
  ds_read_b128 v[76:79], v3 offset:24576
  ds_read_b128 v[80:83], v3 offset:32768
  ds_read_b128 v[84:87], v3 offset:40960
  ds_read_b128 v[88:91], v3 offset:49152
  ds_read_b128 v[92:95], v3 offset:57344
L_c_nopre:
  s_lshr_b32 s61, s3, 1
  s_and_b32 s62, s3, 1
  s_lshl_b32 s57, s28, 4
  s_lshl_b32 s63, s61, 1
  s_add_u32 s57, s57, s63
  s_lshl_b32 s57, s57, 11
  v_lshrrev_b32 v2, 5, v0
  v_lshlrev_b32 v2, 11, v2
  v_and_b32 v3, 31, v0
  v_lshl_add_u32 v3, v3, 4, v2
  s_lshl_b32 s63, s62, 9
  v_add_u32 v3, s63, v3
  s_mov_b32 s80, 0
L_c_poll:
  buffer_load_dwordx4 v[8:11], v3, s[44:47], s57 offen sc1
  buffer_load_dwordx4 v[12:15], v2, s[44:47], s57 offen offset:1024 sc1
  s_waitcnt vmcnt(0)
  v_max3_u32 v6, v8, v9, v10
  v_max3_u32 v6, v6, v11, v12
  v_max3_u32 v6, v6, v13, v14
  v_max_u32 v6, v6, v15
  v_cmp_eq_u32 vcc, -1, v6
  s_nop 1
  s_cbranch_vccz L_c_ok
  s_sleep 1
  s_add_u32 s80, s80, 1
  s_cmp_lt_u32 s80, 262144
  s_nop 1
  s_cbranch_scc1 L_c_poll
L_c_ok:
  s_cmp_eq_u32 s62, 0
  s_cselect_b64 vcc, -1, 0
  v_cndmask_b32 v4, v14, v12, vcc
  v_cndmask_b32 v5, v15, v13, vcc
  v_mov_b32 v6, v4
  s_nop 1
  v_permlane32_swap_b32 v4, v6
  v_mov_b32 v7, v5
  s_nop 1
  v_permlane32_swap_b32 v5, v7
  v_max_f32 v16, v4, v6
  v_sub_f32 v4, v4, v16
  v_sub_f32 v6, v6, v16
  v_mul_f32 v4, s64, v4
  v_mul_f32 v6, s64, v6
  v_exp_f32 v4, v4
  v_exp_f32 v6, v6
  v_mul_f32 v5, v4, v5
  v_fmac_f32 v5, v6, v7
  v_rcp_f32 v7, v5
  v_cmp_gt_u32 vcc, 32, v0
  s_nop 1
  v_cndmask_b32 v4, v6, v4, vcc
  v_fma_f32 v6, -v5, v7, 1.0
  v_fma_f32 v7, v6, v7, v7
  v_mul_f32 v4, v4, v7
  v_mul_f32 v8, v8, v4
  v_mul_f32 v9, v9, v4
  v_mul_f32 v10, v10, v4
  v_mul_f32 v11, v11, v4
  v_mov_b32 v12, v8
  v_mov_b32 v13, v9
  v_mov_b32 v14, v10
  v_mov_b32 v15, v11
  v_permlane32_swap_b32 v8, v12
  v_permlane32_swap_b32 v9, v13
  v_permlane32_swap_b32 v10, v14
  v_permlane32_swap_b32 v11, v15
  v_add_f32 v8, v8, v12
  v_add_f32 v9, v9, v13
  v_add_f32 v10, v10, v14
  v_add_f32 v11, v11, v15
  v_cvt_pk_bf16_f32 v8, v8, v9
  v_cvt_pk_bf16_f32 v9, v10, v11
  s_mul_i32 s57, s61, 544
  s_lshl_b32 s63, s62, 8
  s_add_u32 s57, s57, s63
  v_lshlrev_b32 v3, 3, v0
  v_add_u32 v3, s57, v3
  v_cmp_gt_u32 vcc, 32, v0
  s_nop 0
  s_and_saveexec_b64 s[68:69], vcc
  ds_write_b64 v3, v[8:9] offset:25600
  s_mov_b64 exec, s[68:69]
  s_waitcnt lgkmcnt(0)
  s_barrier
  s_cmp_ge_u32 s3, 8
  s_cbranch_scc1 L_end
  v_and_b32 v2, 7, v0
  s_movk_i32 s57, 544
  v_mul_lo_u32 v2, v2, s57
  v_lshrrev_b32 v3, 4, v0
  v_lshl_add_u32 v2, v3, 4, v2
  ds_read_b128 v[4:7], v2 offset:25600
  ds_read_b128 v[8:11], v2 offset:25664
  ds_read_b128 v[12:15], v2 offset:25728
  ds_read_b128 v[16:19], v2 offset:25792
  ds_read_b128 v[20:23], v2 offset:25856
  ds_read_b128 v[24:27], v2 offset:25920
  ds_read_b128 v[28:31], v2 offset:25984
  ds_read_b128 v[100:103], v2 offset:26048
  s_waitcnt lgkmcnt(7)
  v_mfma_f32_16x16x32_bf16 v[32:35], v[4:7], v[64:67], 0
  s_waitcnt lgkmcnt(6)
  v_mfma_f32_16x16x32_bf16 v[32:35], v[8:11], v[68:71], v[32:35]
  s_waitcnt lgkmcnt(5)
  v_mfma_f32_16x16x32_bf16 v[32:35], v[12:15], v[72:75], v[32:35]
  s_waitcnt lgkmcnt(4)
  v_mfma_f32_16x16x32_bf16 v[32:35], v[16:19], v[76:79], v[32:35]
  s_waitcnt lgkmcnt(3)
  v_mfma_f32_16x16x32_bf16 v[32:35], v[20:23], v[80:83], v[32:35]
  s_waitcnt lgkmcnt(2)
  v_mfma_f32_16x16x32_bf16 v[32:35], v[24:27], v[84:87], v[32:35]
  s_waitcnt lgkmcnt(1)
  v_mfma_f32_16x16x32_bf16 v[32:35], v[28:31], v[88:91], v[32:35]
  s_waitcnt lgkmcnt(0)
  v_mfma_f32_16x16x32_bf16 v[32:35], v[100:103], v[92:95], v[32:35]
  s_mul_i32 s57, s28, 5
  s_add_u32 s57, s57, s29
  s_lshl_b32 s57, s57, 12
  s_lshl_b32 s61, s3, 9
  s_add_u32 s57, s57, s61
  s_add_u32 s57, s57, 524288
  s_nop 1
  v_min_u32 v32, s67, v32
  v_min_u32 v33, s67, v33
  v_min_u32 v34, s67, v34
  v_min_u32 v35, s67, v35
  v_and_b32 v3, 15, v0
  v_lshlrev_b32 v3, 5, v3
  v_lshrrev_b32 v2, 4, v0
  v_lshl_add_u32 v3, v2, 4, v3
  v_cmp_gt_u32 vcc, 32, v0
  s_nop 0
  s_and_saveexec_b64 s[68:69], vcc
  buffer_store_dwordx4 v[32:35], v3, s[44:47], s57 offen sc1
  s_mov_b64 exec, s[68:69]
L_end:
L_exit:
  s_endpgm
.section .rodata,"a"
.p2align 6
.amdhsa_kernel parallel_sum__gqa_block_cached__swiglu_ffn__decode_kernel
  .amdhsa_next_free_vgpr 128
  .amdhsa_next_free_sgpr 100
  .amdhsa_accum_offset 128
  .amdhsa_group_segment_fixed_size 0
  .amdhsa_kernarg_size 96
  .amdhsa_user_sgpr_count 2
  .amdhsa_user_sgpr_kernarg_segment_ptr 1
  .amdhsa_system_sgpr_workgroup_id_x 1
.end_amdhsa_kernel
```
